```python
import torch

def _softmax(x, axis=-1):
    return torch.softmax(x, dim=axis)
def _gelu(x):
    return torch.nn.functional.gelu(x, approximate="tanh")
def _silu(x):
    return torch.nn.functional.silu(x)
def _sigmoid(x):
    return torch.sigmoid(x)
def _layernorm(x, axis=-1, eps=1e-5):
    m = x.mean(dim=axis, keepdim=True)
    v = x.var(dim=axis, keepdim=True, unbiased=False)
    return (x - m) / torch.sqrt(v + eps)
def _scatter_add(tgt, idx, src, axis=0):
    return tgt.clone().index_add_(axis, idx, src)
def _segment_sum(src, seg, n):
    out = torch.zeros((n,) + src.shape[1:], dtype=src.dtype)
    return out.index_add_(0, seg, src)
def _pad(x, pw):
    flat = tuple(v for pair in reversed(pw) for v in pair)
    return torch.nn.functional.pad(x, flat)

kernel_name = 'standalone__glu_gated_swiglu__sampling'

def setup_inputs():

    _w = (lambda a: (lambda t: t.to(torch.bfloat16) if t.is_floating_point() else t)(torch.as_tensor(a)))
    B, S, D, F = 16, 4, 1024, 3584
    return {
        "x": _w((lambda *s: torch.randn(*s, dtype=torch.bfloat16) * 0.05)(B, S, D)),
        "w1": _w((lambda *s: torch.randn(*s, dtype=torch.bfloat16) * 0.05)(D, F) * (2.0 / D) ** 0.5),
        "w3": _w((lambda *s: torch.randn(*s, dtype=torch.bfloat16) * 0.05)(D, F) * (2.0 / D) ** 0.5),
        "w2": _w((lambda *s: torch.randn(*s, dtype=torch.bfloat16) * 0.05)(F, D) * (2.0 / F) ** 0.5),
    }

def reference(x, w1, w3, w2):
    gate = torch.einsum("bsd,df->bsf", x, w1)
    up = torch.einsum("bsd,df->bsf", x, w3)
    h = _silu(gate) * up
    out = torch.einsum("bsf,fd->bsd", h, w2)
    return out
```

```asm
; @launch grid=(256,1,1) block=(512,1,1) lds=163840
.amdgcn_target "amdgcn-amd-amdhsa--gfx950"
.text
.globl standalone__glu_gated_swiglu__sampling_kernel
.p2align 8
.type standalone__glu_gated_swiglu__sampling_kernel,@function
standalone__glu_gated_swiglu__sampling_kernel:
    s_cmp_ge_u32 s2, 256
    s_cbranch_scc1 L_end
    s_load_dwordx8 s[48:55], s[0:1], 0
    s_load_dwordx4 s[56:59], s[0:1], 32
    s_load_dwordx2 s[60:61], s[0:1], 48
    v_lshrrev_b32 v8, 6, v0
    v_and_b32 v0, 63, v0
    v_readfirstlane_b32 s41, v8
    s_and_b32 s32, s2, 7
    s_lshr_b32 s33, s2, 3
    s_and_b32 s34, s33, 1
    s_lshr_b32 s35, s33, 1
    s_and_b32 s3, s35, 1
    s_and_b32 s36, s41, 3
    s_and_b32 s37, s36, 1
    s_lshr_b32 s38, s36, 1
    s_lshr_b32 s43, s33, 2
    s_mul_i32 s42, s32, 7
    s_add_u32 s43, s43, s42
    s_cmp_ge_u32 s41, 4
    s_cbranch_scc1 L_comp
    s_lshl_b32 s44, s36, 10
    s_xor_b32 s6, s34, s3
    v_lshrrev_b32 v8, 3, v0
    v_mul_u32_u24 v1, 7168, v8
    v_and_b32 v8, 2, v8
    v_lshl_or_b32 v8, s37, 2, v8
    v_and_b32 v9, 7, v0
    v_xor_b32 v8, v8, v9
    v_lshl_add_u32 v1, v8, 4, v1
    s_lshl_b32 s39, s43, 7
    s_lshl_b32 s41, s6, 6
    s_add_u32 s41, s41, s36
    s_mul_i32 s41, s41, 57344
    s_add_u32 s39, s39, s41
    s_waitcnt lgkmcnt(0)
    s_cmp_ge_u32 s33, 28
    s_cbranch_scc1 L_hld
    s_cmp_eq_u32 s3, 0
    s_cselect_b32 s46, s50, s52
    s_cselect_b32 s47, s51, s53
    s_mov_b32 s12, s46
    s_and_b32 s13, s47, 0xffff
    s_mov_b32 s14, 7340032
    s_mov_b32 s15, 0x20000
    s_add_u32 m0, s44, 0
    s_add_u32 s41, s39, 0
    buffer_load_dwordx4 v1, s[12:15], s41 offen lds
    s_add_u32 m0, s44, 4096
    s_add_u32 s41, s39, 229376
    buffer_load_dwordx4 v1, s[12:15], s41 offen lds
    s_add_u32 m0, s44, 8192
    s_add_u32 s41, s39, 458752
    buffer_load_dwordx4 v1, s[12:15], s41 offen lds
    s_add_u32 m0, s44, 12288
    s_add_u32 s41, s39, 688128
    buffer_load_dwordx4 v1, s[12:15], s41 offen lds
    v_lshrrev_b32 v8, 4, v0
    v_lshl_or_b32 v8, s36, 2, v8
    v_and_b32 v9, 15, v0
    v_xor_b32 v9, v8, v9
    v_lshlrev_b32 v2, 11, v8
    v_lshl_add_u32 v2, v9, 4, v2
    s_lshl_b32 s40, s34, 16
    s_lshl_b32 s41, s6, 10
    s_add_u32 s40, s40, s41
    s_mov_b32 s8, s48
    s_and_b32 s9, s49, 0xffff
    s_mov_b32 s10, 131072
    s_mov_b32 s11, 0x20000
    s_add_u32 m0, s44, 98304
    s_add_u32 s41, s40, 0
    buffer_load_dwordx4 v2, s[8:11], s41 offen lds
    s_add_u32 m0, s44, 102400
    s_add_u32 s41, s40, 32768
    buffer_load_dwordx4 v2, s[8:11], s41 offen lds
    s_add_u32 m0, s44, 16384
    s_add_u32 s41, s39, 917504
    buffer_load_dwordx4 v1, s[12:15], s41 offen lds
    s_add_u32 m0, s44, 20480
    s_add_u32 s41, s39, 1146880
    buffer_load_dwordx4 v1, s[12:15], s41 offen lds
    s_add_u32 m0, s44, 24576
    s_add_u32 s41, s39, 1376256
    buffer_load_dwordx4 v1, s[12:15], s41 offen lds
    s_add_u32 m0, s44, 28672
    s_add_u32 s41, s39, 1605632
    buffer_load_dwordx4 v1, s[12:15], s41 offen lds
    s_add_u32 m0, s44, 106496
    s_add_u32 s41, s40, 256
    buffer_load_dwordx4 v2, s[8:11], s41 offen lds
    s_add_u32 m0, s44, 110592
    s_add_u32 s41, s40, 33024
    buffer_load_dwordx4 v2, s[8:11], s41 offen lds
    s_mov_b32 s16, s54
    s_and_b32 s17, s55, 0xffff
    s_mov_b32 s18, 7340032
    s_mov_b32 s19, 0x20000
    v_lshrrev_b32 v8, 3, v0
    v_lshlrev_b32 v7, 11, v8
    v_and_b32 v8, 6, v8
    v_and_b32 v9, 7, v0
    v_xor_b32 v8, v8, v9
    v_lshl_add_u32 v7, v8, 4, v7
    s_mul_i32 s45, s32, 56
    s_add_u32 s45, s45, s36
    s_lshl_b32 s45, s45, 14
    s_lshl_b32 s41, s35, 7
    s_add_u32 s45, s45, s41
    s_mov_b32 s28, s60
    s_and_b32 s29, s61, 0xffff
    s_mov_b32 s30, 16777216
    s_mov_b32 s31, 0x20000
    s_mov_b32 s94, 917504
    s_mov_b32 s95, 5242880
    s_mov_b32 s96, 1376256
    s_mov_b32 s97, 5472256
    s_mov_b32 s90, 458752
    s_lshl_b32 s91, s38, 1
    s_lshl_b32 s42, s34, 1
    s_add_u32 s42, s42, s37
    s_mul_i32 s42, s42, 112
    s_lshl_b32 s41, s32, 1
    s_add_u32 s41, s41, s38
    s_mul_i32 s41, s41, 7
    s_add_u32 s41, s41, s42
    s_add_u32 s41, s41, 4
    s_lshl_b32 s41, s41, 10
    v_lshl_add_u32 v10, v0, 4, s41
    s_lshl_b32 s92, s37, 2
    s_add_u32 s92, s92, s91
    s_lshl_b32 s41, s33, 3
    s_add_u32 s41, s41, s92
    s_lshl_b32 s41, s41, 3
    s_add_u32 s41, s41, s32
    s_lshl_b32 s41, s41, 10
    s_add_u32 s41, s41, 2097152
    v_lshl_add_u32 v6, v0, 4, s41
    v_and_b32 v9, 3, v0
    v_lshrrev_b32 v8, 2, v0
    v_lshlrev_b32 v24, 7, v8
    v_and_b32 v8, 6, v8
    v_lshl_add_u32 v24, v8, 4, v24
    v_lshl_add_u32 v24, v9, 3, v24
    s_lshl_b32 s41, s91, 5
    v_xor_b32 v24, s41, v24
    s_lshl_b32 s41, s38, 12
    s_add_u32 s41, s41, 57344
    v_add_u32 v24, s41, v24
    v_xor_b32 v25, 32, v24
    v_xor_b32 v26, 64, v24
    v_xor_b32 v27, 96, v24
    s_xor_b32 s41, s92, 0
    s_mul_i32 s41, s41, 3072
    s_add_u32 s41, s41, 106496
    v_lshl_add_u32 v11, v0, 4, s41
    s_xor_b32 s41, s92, 2
    s_mul_i32 s41, s41, 3072
    s_add_u32 s41, s41, 106496
    v_lshl_add_u32 v3, v0, 4, s41
    s_lshl_b32 s41, s33, 3
    s_add_u32 s41, s41, s32
    s_lshl_b32 s41, s41, 13
    s_add_u32 s41, s41, 2097152
    s_lshl_b32 s42, s36, 8
    s_add_u32 s41, s41, s42
    v_and_b32 v8, 15, v0
    v_lshl_add_u32 v16, v8, 4, s41
    v_lshrrev_b32 v8, 4, v0
    v_lshl_add_u32 v16, v8, 10, v16
    s_lshl_b32 s41, s34, 1
    s_lshr_b32 s42, s32, 2
    s_add_u32 s41, s41, s42
    s_lshl_b32 s41, s41, 15
    s_lshl_b32 s42, s35, 7
    s_add_u32 s41, s41, s42
    s_and_b32 s42, s32, 3
    s_lshl_b32 s42, s42, 5
    s_add_u32 s41, s41, s42
    v_and_b32 v8, 15, v0
    v_lshl_add_u32 v17, v8, 11, s41
    v_lshrrev_b32 v8, 5, v0
    v_lshl_add_u32 v17, v8, 2, v17
    v_lshl_add_u32 v17, s36, 3, v17
    s_movk_i32 s93, 0x1000
    s_mov_b32 s20, s56
    s_and_b32 s21, s57, 0xffff
    s_mov_b32 s22, 131072
    s_mov_b32 s23, 0x20000
    v_mov_b32 v23, 131072
    s_waitcnt vmcnt(6)
    s_barrier
    s_add_u32 m0, s44, 32768
    s_add_u32 s41, s39, 1835008
    buffer_load_dwordx4 v1, s[12:15], s41 offen lds
    s_add_u32 m0, s44, 36864
    s_add_u32 s41, s39, 2064384
    buffer_load_dwordx4 v1, s[12:15], s41 offen lds
    s_add_u32 m0, s44, 40960
    s_add_u32 s41, s39, 2293760
    buffer_load_dwordx4 v1, s[12:15], s41 offen lds
    s_add_u32 m0, s44, 45056
    s_add_u32 s41, s39, 2523136
    buffer_load_dwordx4 v1, s[12:15], s41 offen lds
    s_add_u32 m0, s44, 114688
    s_add_u32 s41, s40, 512
    buffer_load_dwordx4 v2, s[8:11], s41 offen lds
    s_add_u32 m0, s44, 118784
    s_add_u32 s41, s40, 33280
    buffer_load_dwordx4 v2, s[8:11], s41 offen lds
    s_waitcnt vmcnt(6)
    s_barrier
    s_add_u32 m0, s44, 49152
    s_add_u32 s41, s39, 2752512
    buffer_load_dwordx4 v1, s[12:15], s41 offen lds
    s_add_u32 m0, s44, 53248
    s_add_u32 s41, s39, 2981888
    buffer_load_dwordx4 v1, s[12:15], s41 offen lds
    s_add_u32 m0, s44, 57344
    s_add_u32 s41, s39, 3211264
    buffer_load_dwordx4 v1, s[12:15], s41 offen lds
    s_add_u32 m0, s44, 61440
    s_add_u32 s41, s39, 3440640
    buffer_load_dwordx4 v1, s[12:15], s41 offen lds
    s_add_u32 m0, s44, 122880
    s_add_u32 s41, s40, 768
    buffer_load_dwordx4 v2, s[8:11], s41 offen lds
    s_add_u32 m0, s44, 126976
    s_add_u32 s41, s40, 33536
    buffer_load_dwordx4 v2, s[8:11], s41 offen lds
    s_mul_i32 s41, s6, 7340032
    s_sub_u32 s39, s39, s41
    s_add_u32 m0, s44, 65536
    s_add_u32 s41, s39, 3670016
    buffer_load_dwordx4 v1, s[12:15], s41 offen lds
    s_add_u32 m0, s44, 69632
    s_add_u32 s41, s39, 3899392
    buffer_load_dwordx4 v1, s[12:15], s41 offen lds
    s_add_u32 m0, s44, 73728
    s_add_u32 s41, s39, 4128768
    buffer_load_dwordx4 v1, s[12:15], s41 offen lds
    s_add_u32 m0, s44, 77824
    s_add_u32 s41, s39, 4358144
    buffer_load_dwordx4 v1, s[12:15], s41 offen lds
    s_waitcnt vmcnt(10)
    s_barrier
    s_lshl_b32 s41, s6, 11
    s_sub_u32 s40, s40, s41
    s_add_u32 m0, s44, 131072
    s_add_u32 s41, s40, 1024
    buffer_load_dwordx4 v2, s[8:11], s41 offen lds
    s_add_u32 m0, s44, 135168
    s_add_u32 s41, s40, 33792
    buffer_load_dwordx4 v2, s[8:11], s41 offen lds
    s_add_u32 m0, s44, 81920
    s_add_u32 s41, s39, 4587520
    buffer_load_dwordx4 v1, s[12:15], s41 offen lds
    s_add_u32 m0, s44, 86016
    s_add_u32 s41, s39, 4816896
    buffer_load_dwordx4 v1, s[12:15], s41 offen lds
    s_add_u32 m0, s44, 90112
    s_add_u32 s41, s39, 5046272
    buffer_load_dwordx4 v1, s[12:15], s41 offen lds
    s_add_u32 m0, s44, 94208
    s_add_u32 s41, s39, 5275648
    buffer_load_dwordx4 v1, s[12:15], s41 offen lds
    s_waitcnt vmcnt(10)
    s_barrier
    s_add_u32 m0, s44, 139264
    s_add_u32 s41, s40, 1280
    buffer_load_dwordx4 v2, s[8:11], s41 offen lds
    s_add_u32 m0, s44, 143360
    s_add_u32 s41, s40, 34048
    buffer_load_dwordx4 v2, s[8:11], s41 offen lds
    s_add_u32 m0, s44, 0
    s_add_u32 s41, s39, 5505024
    buffer_load_dwordx4 v1, s[12:15], s41 offen lds
    s_add_u32 m0, s44, 4096
    s_add_u32 s41, s39, 5734400
    buffer_load_dwordx4 v1, s[12:15], s41 offen lds
    s_add_u32 m0, s44, 8192
    s_add_u32 s41, s39, 5963776
    buffer_load_dwordx4 v1, s[12:15], s41 offen lds
    s_add_u32 m0, s44, 12288
    s_add_u32 s41, s39, 6193152
    buffer_load_dwordx4 v1, s[12:15], s41 offen lds
    s_waitcnt vmcnt(10)
    s_barrier
    s_add_u32 m0, s44, 147456
    s_add_u32 s41, s40, 1536
    buffer_load_dwordx4 v2, s[8:11], s41 offen lds
    s_add_u32 m0, s44, 151552
    s_add_u32 s41, s40, 34304
    buffer_load_dwordx4 v2, s[8:11], s41 offen lds
    s_add_u32 m0, s44, 16384
    s_add_u32 s41, s39, 6422528
    buffer_load_dwordx4 v1, s[12:15], s41 offen lds
    s_add_u32 m0, s44, 20480
    s_add_u32 s41, s39, 6651904
    buffer_load_dwordx4 v1, s[12:15], s41 offen lds
    s_add_u32 m0, s44, 24576
    s_add_u32 s41, s39, 6881280
    buffer_load_dwordx4 v1, s[12:15], s41 offen lds
    s_add_u32 m0, s44, 28672
    s_add_u32 s41, s39, 7110656
    buffer_load_dwordx4 v1, s[12:15], s41 offen lds
    s_waitcnt vmcnt(10)
    s_barrier
    s_add_u32 m0, s44, 155648
    s_add_u32 s41, s40, 1792
    buffer_load_dwordx4 v2, s[8:11], s41 offen lds
    s_add_u32 m0, s44, 159744
    s_add_u32 s41, s40, 34560
    buffer_load_dwordx4 v2, s[8:11], s41 offen lds
    s_mul_i32 s39, s34, 458752
    s_add_u32 s39, s39, s45
    s_lshl_b32 s40, s34, 12
    s_add_u32 s40, s40, s44
    s_add_u32 m0, s40, 98304
    s_add_u32 s42, s39, 0
    buffer_load_dwordx4 v7, s[16:19], s42 offen lds
    s_add_u32 m0, s40, 32768
    s_add_u32 s42, s39, 65536
    buffer_load_dwordx4 v7, s[16:19], s42 offen lds
    s_add_u32 m0, s40, 40960
    s_add_u32 s42, s39, 131072
    buffer_load_dwordx4 v7, s[16:19], s42 offen lds
    s_add_u32 m0, s40, 49152
    s_add_u32 s42, s39, 196608
    buffer_load_dwordx4 v7, s[16:19], s42 offen lds
    s_add_u32 m0, s40, 57344
    s_add_u32 s42, s39, 262144
    buffer_load_dwordx4 v7, s[16:19], s42 offen lds
    s_add_u32 m0, s40, 65536
    s_add_u32 s42, s39, 327680
    buffer_load_dwordx4 v7, s[16:19], s42 offen lds
    s_add_u32 m0, s40, 73728
    s_add_u32 s42, s39, 393216
    buffer_load_dwordx4 v7, s[16:19], s42 offen lds
    s_xor_b32 s7, s34, 1
    s_mul_i32 s39, s7, 458752
    s_add_u32 s39, s39, s45
    s_xor_b32 s40, s40, 4096
    s_add_u32 m0, s40, 98304
    s_add_u32 s42, s39, 0
    buffer_load_dwordx4 v7, s[16:19], s42 offen lds
    s_waitcnt vmcnt(14)
    s_barrier
    s_waitcnt vmcnt(8)
    s_barrier
    s_add_u32 m0, s40, 32768
    s_add_u32 s42, s39, 65536
    buffer_load_dwordx4 v7, s[16:19], s42 offen lds
    s_add_u32 m0, s40, 40960
    s_add_u32 s42, s39, 131072
    buffer_load_dwordx4 v7, s[16:19], s42 offen lds
    s_add_u32 m0, s40, 49152
    s_add_u32 s42, s39, 196608
    buffer_load_dwordx4 v7, s[16:19], s42 offen lds
    s_add_u32 m0, s40, 57344
    s_add_u32 s42, s39, 262144
    buffer_load_dwordx4 v7, s[16:19], s42 offen lds
    s_add_u32 m0, s40, 65536
    s_add_u32 s42, s39, 327680
    buffer_load_dwordx4 v7, s[16:19], s42 offen lds
    s_add_u32 m0, s40, 73728
    s_add_u32 s42, s39, 393216
    buffer_load_dwordx4 v7, s[16:19], s42 offen lds
    s_waitcnt vmcnt(0)
    s_barrier
    s_branch L_p2_0
L_hld:
    s_mov_b32 s16, s54
    s_and_b32 s17, s55, 0xffff
    s_mov_b32 s18, 7340032
    s_mov_b32 s19, 0x20000
    s_sub_u32 s41, s33, 28
    s_lshl_b32 s41, s41, 2
    s_add_u32 s41, s41, s36
    s_mul_i32 s42, s32, 224
    s_add_u32 s41, s41, s42
    s_lshl_b32 s41, s41, 12
    v_lshrrev_b32 v8, 5, v0
    v_mul_u32_u24 v1, 454656, v8
    v_lshl_add_u32 v1, v0, 7, v1
    s_barrier
    s_cmp_eq_u32 s3, 0
    s_cselect_b32 s46, s50, s52
    s_cselect_b32 s47, s51, s53
    s_mov_b32 s12, s46
    s_and_b32 s13, s47, 0xffff
    s_mov_b32 s14, 7340032
    s_mov_b32 s15, 0x20000
    s_add_u32 s39, s32, 3
    s_and_b32 s39, s39, 7
    s_cmp_eq_u32 s39, 7
    s_cbranch_scc1 L_npc
    s_mul_i32 s40, s32, 7
    s_add_u32 s39, s39, s40
    s_lshl_b32 s39, s39, 7
    s_lshl_b32 s40, s34, 3
    s_add_u32 s40, s40, s36
    s_add_u32 s40, s40, 4
    s_mul_i32 s40, s40, 458752
    s_add_u32 s39, s39, s40
    v_mul_u32_u24 v8, 7168, v0
    buffer_load_dword v2, v8, s[12:15], s39 offen
L_npc:
    s_sub_u32 s39, s33, 28
    s_lshl_b32 s39, s39, 2
    s_add_u32 s39, s39, s36
    s_mul_i32 s39, s39, 28
    s_mul_i32 s40, s32, 448
    s_add_u32 s39, s39, s40
    s_lshl_b32 s39, s39, 11
    s_add_u32 s39, s39, 384
    v_lshlrev_b32 v8, 10, v0
    s_mov_b32 exec_hi, 0x00ffffff
    buffer_load_dword v2, v8, s[16:19], s39 offen
    s_mov_b32 exec_lo, 4160223223
    s_mov_b32 exec_hi, 4160223223
    buffer_load_dword v2, v1, s[16:19], s41 offen
    s_add_u32 s41, s41, 65536
    s_mov_b64 exec, -1
    v_lshrrev_b32 v8, 3, v0
    v_lshlrev_b32 v7, 11, v8
    v_and_b32 v8, 6, v8
    v_and_b32 v9, 7, v0
    v_xor_b32 v8, v8, v9
    v_lshl_add_u32 v7, v8, 4, v7
    s_mul_i32 s45, s32, 56
    s_add_u32 s45, s45, s36
    s_lshl_b32 s45, s45, 14
    s_lshl_b32 s41, s35, 7
    s_add_u32 s45, s45, s41
    s_mul_i32 s39, s34, 458752
    s_add_u32 s39, s39, s45
    s_lshl_b32 s40, s34, 12
    s_add_u32 s40, s40, s44
    s_add_u32 m0, s40, 98304
    s_add_u32 s42, s39, 0
    buffer_load_dwordx4 v7, s[16:19], s42 offen lds
    s_add_u32 m0, s40, 32768
    s_add_u32 s42, s39, 65536
    buffer_load_dwordx4 v7, s[16:19], s42 offen lds
    s_add_u32 m0, s40, 40960
    s_add_u32 s42, s39, 131072
    buffer_load_dwordx4 v7, s[16:19], s42 offen lds
    s_add_u32 m0, s40, 49152
    s_add_u32 s42, s39, 196608
    buffer_load_dwordx4 v7, s[16:19], s42 offen lds
    s_add_u32 m0, s40, 57344
    s_add_u32 s42, s39, 262144
    buffer_load_dwordx4 v7, s[16:19], s42 offen lds
    s_add_u32 m0, s40, 65536
    s_add_u32 s42, s39, 327680
    buffer_load_dwordx4 v7, s[16:19], s42 offen lds
    s_add_u32 m0, s40, 73728
    s_add_u32 s42, s39, 393216
    buffer_load_dwordx4 v7, s[16:19], s42 offen lds
    s_xor_b32 s7, s34, 1
    s_mul_i32 s39, s7, 458752
    s_add_u32 s39, s39, s45
    s_xor_b32 s40, s40, 4096
    s_add_u32 m0, s40, 98304
    s_add_u32 s42, s39, 0
    buffer_load_dwordx4 v7, s[16:19], s42 offen lds
    s_add_u32 m0, s40, 32768
    s_add_u32 s42, s39, 65536
    buffer_load_dwordx4 v7, s[16:19], s42 offen lds
    s_add_u32 m0, s40, 40960
    s_add_u32 s42, s39, 131072
    buffer_load_dwordx4 v7, s[16:19], s42 offen lds
    s_add_u32 m0, s40, 49152
    s_add_u32 s42, s39, 196608
    buffer_load_dwordx4 v7, s[16:19], s42 offen lds
    s_add_u32 m0, s40, 57344
    s_add_u32 s42, s39, 262144
    buffer_load_dwordx4 v7, s[16:19], s42 offen lds
    s_add_u32 m0, s40, 65536
    s_add_u32 s42, s39, 327680
    buffer_load_dwordx4 v7, s[16:19], s42 offen lds
    s_add_u32 m0, s40, 73728
    s_add_u32 s42, s39, 393216
    buffer_load_dwordx4 v7, s[16:19], s42 offen lds
    s_mov_b32 s28, s60
    s_and_b32 s29, s61, 0xffff
    s_mov_b32 s30, 16777216
    s_mov_b32 s31, 0x20000
    s_mov_b32 s94, 917504
    s_mov_b32 s95, 5242880
    s_mov_b32 s96, 1376256
    s_mov_b32 s97, 5472256
    s_mov_b32 s90, 458752
    s_lshl_b32 s91, s38, 1
    s_lshl_b32 s42, s34, 1
    s_add_u32 s42, s42, s37
    s_mul_i32 s42, s42, 112
    s_lshl_b32 s41, s32, 1
    s_add_u32 s41, s41, s38
    s_mul_i32 s41, s41, 7
    s_add_u32 s41, s41, s42
    s_add_u32 s41, s41, 4
    s_lshl_b32 s41, s41, 10
    v_lshl_add_u32 v10, v0, 4, s41
    s_lshl_b32 s92, s37, 2
    s_add_u32 s92, s92, s91
    s_lshl_b32 s41, s33, 3
    s_add_u32 s41, s41, s92
    s_lshl_b32 s41, s41, 3
    s_add_u32 s41, s41, s32
    s_lshl_b32 s41, s41, 10
    s_add_u32 s41, s41, 2097152
    v_lshl_add_u32 v6, v0, 4, s41
    v_and_b32 v9, 3, v0
    v_lshrrev_b32 v8, 2, v0
    v_lshlrev_b32 v24, 7, v8
    v_and_b32 v8, 6, v8
    v_lshl_add_u32 v24, v8, 4, v24
    v_lshl_add_u32 v24, v9, 3, v24
    s_lshl_b32 s41, s91, 5
    v_xor_b32 v24, s41, v24
    s_lshl_b32 s41, s38, 12
    s_add_u32 s41, s41, 57344
    v_add_u32 v24, s41, v24
    v_xor_b32 v25, 32, v24
    v_xor_b32 v26, 64, v24
    v_xor_b32 v27, 96, v24
    s_xor_b32 s41, s92, 0
    s_mul_i32 s41, s41, 3072
    s_add_u32 s41, s41, 106496
    v_lshl_add_u32 v11, v0, 4, s41
    s_xor_b32 s41, s92, 2
    s_mul_i32 s41, s41, 3072
    s_add_u32 s41, s41, 106496
    v_lshl_add_u32 v3, v0, 4, s41
    s_lshl_b32 s41, s33, 3
    s_add_u32 s41, s41, s32
    s_lshl_b32 s41, s41, 13
    s_add_u32 s41, s41, 2097152
    s_lshl_b32 s42, s36, 8
    s_add_u32 s41, s41, s42
    v_and_b32 v8, 15, v0
    v_lshl_add_u32 v16, v8, 4, s41
    v_lshrrev_b32 v8, 4, v0
    v_lshl_add_u32 v16, v8, 10, v16
    s_lshl_b32 s41, s34, 1
    s_lshr_b32 s42, s32, 2
    s_add_u32 s41, s41, s42
    s_lshl_b32 s41, s41, 15
    s_lshl_b32 s42, s35, 7
    s_add_u32 s41, s41, s42
    s_and_b32 s42, s32, 3
    s_lshl_b32 s42, s42, 5
    s_add_u32 s41, s41, s42
    v_and_b32 v8, 15, v0
    v_lshl_add_u32 v17, v8, 11, s41
    v_lshrrev_b32 v8, 5, v0
    v_lshl_add_u32 v17, v8, 2, v17
    v_lshl_add_u32 v17, s36, 3, v17
    s_movk_i32 s93, 0x1000
    s_mov_b32 s20, s56
    s_and_b32 s21, s57, 0xffff
    s_mov_b32 s22, 131072
    s_mov_b32 s23, 0x20000
    v_mov_b32 v23, 131072
    s_waitcnt vmcnt(0)
    s_barrier
    s_barrier
    s_branch L_p2_0
L_comp:
    s_waitcnt lgkmcnt(0)
    s_mov_b32 s28, s60
    s_and_b32 s29, s61, 0xffff
    s_mov_b32 s30, 16777216
    s_mov_b32 s31, 0x20000
    s_mov_b32 s24, s58
    s_and_b32 s25, s59, 0xffff
    s_mov_b32 s26, 256
    s_mov_b32 s27, 0x20000
    s_mov_b32 s20, s56
    s_and_b32 s21, s57, 0xffff
    s_mov_b32 s22, 131072
    s_mov_b32 s23, 0x20000
    s_cmp_ge_u32 s33, 28
    s_cbranch_scc1 L_hcp
    s_lshl_b32 s42, s34, 1
    s_add_u32 s42, s42, s37
    s_mul_i32 s42, s42, 112
    s_mul_i32 s41, s3, 448
    s_add_u32 s41, s41, s42
    s_lshl_b32 s42, s43, 1
    s_add_u32 s41, s41, s42
    s_add_u32 s41, s41, s38
    s_lshl_b32 s41, s41, 10
    v_lshl_add_u32 v5, v0, 4, s41
    s_mov_b32 s94, 917504
    s_mov_b32 s95, 5242880
    s_mov_b32 s96, 1376256
    s_mov_b32 s97, 5472256
    s_mov_b32 s90, 458752
    s_lshl_b32 s91, s38, 1
    s_lshl_b32 s42, s34, 1
    s_add_u32 s42, s42, s37
    s_mul_i32 s42, s42, 112
    s_lshl_b32 s41, s32, 1
    s_add_u32 s41, s41, s38
    s_mul_i32 s41, s41, 7
    s_add_u32 s41, s41, s42
    s_add_u32 s41, s41, 0
    s_lshl_b32 s41, s41, 10
    v_lshl_add_u32 v10, v0, 4, s41
    s_lshl_b32 s92, s37, 2
    s_add_u32 s92, s92, s91
    s_lshl_b32 s41, s33, 3
    s_add_u32 s41, s41, s92
    s_lshl_b32 s41, s41, 3
    s_add_u32 s41, s41, s32
    s_lshl_b32 s41, s41, 10
    s_add_u32 s41, s41, 2097152
    v_lshl_add_u32 v6, v0, 4, s41
    v_and_b32 v9, 3, v0
    v_lshrrev_b32 v8, 2, v0
    v_lshlrev_b32 v24, 7, v8
    v_and_b32 v8, 6, v8
    v_lshl_add_u32 v24, v8, 4, v24
    v_lshl_add_u32 v24, v9, 3, v24
    s_lshl_b32 s41, s91, 5
    v_xor_b32 v24, s41, v24
    s_lshl_b32 s41, s38, 12
    s_add_u32 s41, s41, 32768
    v_add_u32 v24, s41, v24
    v_xor_b32 v25, 32, v24
    v_xor_b32 v26, 64, v24
    v_xor_b32 v27, 96, v24
    v_add_u32 v28, 0x10000, v24
    v_add_u32 v29, 0x10000, v25
    v_add_u32 v30, 0x10000, v26
    v_add_u32 v31, 0x10000, v27
    s_xor_b32 s41, s92, 0
    s_mul_i32 s41, s41, 3072
    s_add_u32 s41, s41, 106496
    v_lshl_add_u32 v11, v0, 4, s41
    s_xor_b32 s41, s92, 2
    s_mul_i32 s41, s41, 3072
    s_add_u32 s41, s41, 106496
    v_lshl_add_u32 v3, v0, 4, s41
    v_mov_b32 v23, 131072
    v_lshrrev_b32 v8, 4, v0
    v_lshlrev_b32 v12, 10, v8
    v_and_b32 v8, 12, v0
    v_lshl_add_u32 v12, v8, 5, v12
    v_lshrrev_b32 v8, 3, v0
    v_and_b32 v8, 3, v8
    s_lshl_b32 s41, s38, 1
    v_xor_b32 v8, s41, v8
    v_lshl_add_u32 v12, v8, 5, v12
    v_and_b32 v9, 3, v0
    v_lshl_add_u32 v12, v9, 3, v12
    v_xor_b32 v13, 32, v12
    v_add_u32 v14, 0x10000, v12
    v_add_u32 v15, 0x10000, v13
    v_and_b32 v8, 15, v0
    v_lshrrev_b32 v9, 4, v0
    v_xor_b32 v9, v8, v9
    v_lshlrev_b32 v8, 8, v8
    v_lshl_add_u32 v18, v9, 4, v8
    s_lshl_b32 s41, s37, 12
    s_add_u32 s41, s41, 98304
    v_add_u32 v18, s41, v18
    v_xor_b32 v19, 64, v18
    v_xor_b32 v20, 128, v18
    v_xor_b32 v21, 192, v18
    s_barrier
    ds_read_b128 v[64:67], v18 offset:0
    ds_read_b64_tr_b16 v[68:69], v12 offset:0
    ds_read_b64_tr_b16 v[70:71], v12 offset:512
    ds_read_b64_tr_b16 v[72:73], v13 offset:0
    ds_read_b64_tr_b16 v[74:75], v13 offset:512
    ds_read_b128 v[76:79], v19 offset:0
    ds_read_b64_tr_b16 v[80:81], v12 offset:4096
    ds_read_b64_tr_b16 v[82:83], v12 offset:4608
    ds_read_b64_tr_b16 v[84:85], v13 offset:4096
    ds_read_b64_tr_b16 v[86:87], v13 offset:4608
    ds_read_b128 v[88:91], v20 offset:0
    ds_read_b64_tr_b16 v[92:93], v12 offset:8192
    ds_read_b64_tr_b16 v[94:95], v12 offset:8704
    ds_read_b64_tr_b16 v[96:97], v13 offset:8192
    ds_read_b64_tr_b16 v[98:99], v13 offset:8704
    s_waitcnt lgkmcnt(10)
    v_mfma_f32_16x16x32_bf16 v[32:35], v[68:71], v[64:67], 0
    v_mfma_f32_16x16x32_bf16 v[36:39], v[72:75], v[64:67], 0
    ds_read_b128 v[100:103], v21 offset:0
    ds_read_b64_tr_b16 v[104:105], v12 offset:12288
    ds_read_b64_tr_b16 v[106:107], v12 offset:12800
    ds_read_b64_tr_b16 v[108:109], v13 offset:12288
    ds_read_b64_tr_b16 v[110:111], v13 offset:12800
    s_waitcnt lgkmcnt(10)
    v_mfma_f32_16x16x32_bf16 v[32:35], v[80:83], v[76:79], v[32:35]
    v_mfma_f32_16x16x32_bf16 v[36:39], v[84:87], v[76:79], v[36:39]
    s_waitcnt lgkmcnt(5)
    v_mfma_f32_16x16x32_bf16 v[32:35], v[92:95], v[88:91], v[32:35]
    v_mfma_f32_16x16x32_bf16 v[36:39], v[96:99], v[88:91], v[36:39]
    s_waitcnt lgkmcnt(0)
    v_mfma_f32_16x16x32_bf16 v[32:35], v[104:107], v[100:103], v[32:35]
    v_mfma_f32_16x16x32_bf16 v[36:39], v[108:111], v[100:103], v[36:39]
    s_barrier
    ds_read_b128 v[64:67], v18 offset:8192
    ds_read_b64_tr_b16 v[68:69], v12 offset:16384
    ds_read_b64_tr_b16 v[70:71], v12 offset:16896
    ds_read_b64_tr_b16 v[72:73], v13 offset:16384
    ds_read_b64_tr_b16 v[74:75], v13 offset:16896
    ds_read_b128 v[76:79], v19 offset:8192
    ds_read_b64_tr_b16 v[80:81], v12 offset:20480
    ds_read_b64_tr_b16 v[82:83], v12 offset:20992
    ds_read_b64_tr_b16 v[84:85], v13 offset:20480
    ds_read_b64_tr_b16 v[86:87], v13 offset:20992
    ds_read_b128 v[88:91], v20 offset:8192
    ds_read_b64_tr_b16 v[92:93], v12 offset:24576
    ds_read_b64_tr_b16 v[94:95], v12 offset:25088
    ds_read_b64_tr_b16 v[96:97], v13 offset:24576
    ds_read_b64_tr_b16 v[98:99], v13 offset:25088
    s_waitcnt lgkmcnt(10)
    v_mfma_f32_16x16x32_bf16 v[32:35], v[68:71], v[64:67], v[32:35]
    v_mfma_f32_16x16x32_bf16 v[36:39], v[72:75], v[64:67], v[36:39]
    ds_read_b128 v[100:103], v21 offset:8192
    ds_read_b64_tr_b16 v[104:105], v12 offset:28672
    ds_read_b64_tr_b16 v[106:107], v12 offset:29184
    ds_read_b64_tr_b16 v[108:109], v13 offset:28672
    ds_read_b64_tr_b16 v[110:111], v13 offset:29184
    s_waitcnt lgkmcnt(10)
    v_mfma_f32_16x16x32_bf16 v[32:35], v[80:83], v[76:79], v[32:35]
    v_mfma_f32_16x16x32_bf16 v[36:39], v[84:87], v[76:79], v[36:39]
    s_waitcnt lgkmcnt(5)
    v_mfma_f32_16x16x32_bf16 v[32:35], v[92:95], v[88:91], v[32:35]
    v_mfma_f32_16x16x32_bf16 v[36:39], v[96:99], v[88:91], v[36:39]
    s_waitcnt lgkmcnt(0)
    v_mfma_f32_16x16x32_bf16 v[32:35], v[104:107], v[100:103], v[32:35]
    v_mfma_f32_16x16x32_bf16 v[36:39], v[108:111], v[100:103], v[36:39]
    s_barrier
    ds_read_b128 v[64:67], v18 offset:16384
    ds_read_b64_tr_b16 v[68:69], v12 offset:32768
    ds_read_b64_tr_b16 v[70:71], v12 offset:33280
    ds_read_b64_tr_b16 v[72:73], v13 offset:32768
    ds_read_b64_tr_b16 v[74:75], v13 offset:33280
    ds_read_b128 v[76:79], v19 offset:16384
    ds_read_b64_tr_b16 v[80:81], v12 offset:36864
    ds_read_b64_tr_b16 v[82:83], v12 offset:37376
    ds_read_b64_tr_b16 v[84:85], v13 offset:36864
    ds_read_b64_tr_b16 v[86:87], v13 offset:37376
    ds_read_b128 v[88:91], v20 offset:16384
    ds_read_b64_tr_b16 v[92:93], v12 offset:40960
    ds_read_b64_tr_b16 v[94:95], v12 offset:41472
    ds_read_b64_tr_b16 v[96:97], v13 offset:40960
    ds_read_b64_tr_b16 v[98:99], v13 offset:41472
    s_waitcnt lgkmcnt(10)
    v_mfma_f32_16x16x32_bf16 v[32:35], v[68:71], v[64:67], v[32:35]
    v_mfma_f32_16x16x32_bf16 v[36:39], v[72:75], v[64:67], v[36:39]
    ds_read_b128 v[100:103], v21 offset:16384
    ds_read_b64_tr_b16 v[104:105], v12 offset:45056
    ds_read_b64_tr_b16 v[106:107], v12 offset:45568
    ds_read_b64_tr_b16 v[108:109], v13 offset:45056
    ds_read_b64_tr_b16 v[110:111], v13 offset:45568
    s_waitcnt lgkmcnt(10)
    v_mfma_f32_16x16x32_bf16 v[32:35], v[80:83], v[76:79], v[32:35]
    v_mfma_f32_16x16x32_bf16 v[36:39], v[84:87], v[76:79], v[36:39]
    s_waitcnt lgkmcnt(5)
    v_mfma_f32_16x16x32_bf16 v[32:35], v[92:95], v[88:91], v[32:35]
    v_mfma_f32_16x16x32_bf16 v[36:39], v[96:99], v[88:91], v[36:39]
    s_waitcnt lgkmcnt(0)
    v_mfma_f32_16x16x32_bf16 v[32:35], v[104:107], v[100:103], v[32:35]
    v_mfma_f32_16x16x32_bf16 v[36:39], v[108:111], v[100:103], v[36:39]
    s_barrier
    ds_read_b128 v[64:67], v18 offset:24576
    ds_read_b64_tr_b16 v[68:69], v12 offset:49152
    ds_read_b64_tr_b16 v[70:71], v12 offset:49664
    ds_read_b64_tr_b16 v[72:73], v13 offset:49152
    ds_read_b64_tr_b16 v[74:75], v13 offset:49664
    ds_read_b128 v[76:79], v19 offset:24576
    ds_read_b64_tr_b16 v[80:81], v12 offset:53248
    ds_read_b64_tr_b16 v[82:83], v12 offset:53760
    ds_read_b64_tr_b16 v[84:85], v13 offset:53248
    ds_read_b64_tr_b16 v[86:87], v13 offset:53760
    ds_read_b128 v[88:91], v20 offset:24576
    ds_read_b64_tr_b16 v[92:93], v12 offset:57344
    ds_read_b64_tr_b16 v[94:95], v12 offset:57856
    ds_read_b64_tr_b16 v[96:97], v13 offset:57344
    ds_read_b64_tr_b16 v[98:99], v13 offset:57856
    s_waitcnt lgkmcnt(10)
    v_mfma_f32_16x16x32_bf16 v[32:35], v[68:71], v[64:67], v[32:35]
    v_mfma_f32_16x16x32_bf16 v[36:39], v[72:75], v[64:67], v[36:39]
    ds_read_b128 v[100:103], v21 offset:24576
    ds_read_b64_tr_b16 v[104:105], v12 offset:61440
    ds_read_b64_tr_b16 v[106:107], v12 offset:61952
    ds_read_b64_tr_b16 v[108:109], v13 offset:61440
    ds_read_b64_tr_b16 v[110:111], v13 offset:61952
    s_waitcnt lgkmcnt(10)
    v_mfma_f32_16x16x32_bf16 v[32:35], v[80:83], v[76:79], v[32:35]
    v_mfma_f32_16x16x32_bf16 v[36:39], v[84:87], v[76:79], v[36:39]
    s_waitcnt lgkmcnt(5)
    v_mfma_f32_16x16x32_bf16 v[32:35], v[92:95], v[88:91], v[32:35]
    v_mfma_f32_16x16x32_bf16 v[36:39], v[96:99], v[88:91], v[36:39]
    s_waitcnt lgkmcnt(0)
    v_mfma_f32_16x16x32_bf16 v[32:35], v[104:107], v[100:103], v[32:35]
    v_mfma_f32_16x16x32_bf16 v[36:39], v[108:111], v[100:103], v[36:39]
    s_barrier
    ds_read_b128 v[64:67], v18 offset:32768
    ds_read_b64_tr_b16 v[68:69], v14 offset:0
    ds_read_b64_tr_b16 v[70:71], v14 offset:512
    ds_read_b64_tr_b16 v[72:73], v15 offset:0
    ds_read_b64_tr_b16 v[74:75], v15 offset:512
    ds_read_b128 v[76:79], v19 offset:32768
    ds_read_b64_tr_b16 v[80:81], v14 offset:4096
    ds_read_b64_tr_b16 v[82:83], v14 offset:4608
    ds_read_b64_tr_b16 v[84:85], v15 offset:4096
    ds_read_b64_tr_b16 v[86:87], v15 offset:4608
    ds_read_b128 v[88:91], v20 offset:32768
    ds_read_b64_tr_b16 v[92:93], v14 offset:8192
    ds_read_b64_tr_b16 v[94:95], v14 offset:8704
    ds_read_b64_tr_b16 v[96:97], v15 offset:8192
    ds_read_b64_tr_b16 v[98:99], v15 offset:8704
    s_waitcnt lgkmcnt(10)
    v_mfma_f32_16x16x32_bf16 v[32:35], v[68:71], v[64:67], v[32:35]
    v_mfma_f32_16x16x32_bf16 v[36:39], v[72:75], v[64:67], v[36:39]
    ds_read_b128 v[100:103], v21 offset:32768
    ds_read_b64_tr_b16 v[104:105], v14 offset:12288
    ds_read_b64_tr_b16 v[106:107], v14 offset:12800
    ds_read_b64_tr_b16 v[108:109], v15 offset:12288
    ds_read_b64_tr_b16 v[110:111], v15 offset:12800
    s_waitcnt lgkmcnt(10)
    v_mfma_f32_16x16x32_bf16 v[32:35], v[80:83], v[76:79], v[32:35]
    v_mfma_f32_16x16x32_bf16 v[36:39], v[84:87], v[76:79], v[36:39]
    s_waitcnt lgkmcnt(5)
    v_mfma_f32_16x16x32_bf16 v[32:35], v[92:95], v[88:91], v[32:35]
    v_mfma_f32_16x16x32_bf16 v[36:39], v[96:99], v[88:91], v[36:39]
    s_waitcnt lgkmcnt(0)
    v_mfma_f32_16x16x32_bf16 v[32:35], v[104:107], v[100:103], v[32:35]
    v_mfma_f32_16x16x32_bf16 v[36:39], v[108:111], v[100:103], v[36:39]
    s_barrier
    ds_read_b128 v[64:67], v18 offset:40960
    ds_read_b64_tr_b16 v[68:69], v14 offset:16384
    ds_read_b64_tr_b16 v[70:71], v14 offset:16896
    ds_read_b64_tr_b16 v[72:73], v15 offset:16384
    ds_read_b64_tr_b16 v[74:75], v15 offset:16896
    ds_read_b128 v[76:79], v19 offset:40960
    ds_read_b64_tr_b16 v[80:81], v14 offset:20480
    ds_read_b64_tr_b16 v[82:83], v14 offset:20992
    ds_read_b64_tr_b16 v[84:85], v15 offset:20480
    ds_read_b64_tr_b16 v[86:87], v15 offset:20992
    ds_read_b128 v[88:91], v20 offset:40960
    ds_read_b64_tr_b16 v[92:93], v14 offset:24576
    ds_read_b64_tr_b16 v[94:95], v14 offset:25088
    ds_read_b64_tr_b16 v[96:97], v15 offset:24576
    ds_read_b64_tr_b16 v[98:99], v15 offset:25088
    s_waitcnt lgkmcnt(10)
    v_mfma_f32_16x16x32_bf16 v[32:35], v[68:71], v[64:67], v[32:35]
    v_mfma_f32_16x16x32_bf16 v[36:39], v[72:75], v[64:67], v[36:39]
    ds_read_b128 v[100:103], v21 offset:40960
    ds_read_b64_tr_b16 v[104:105], v14 offset:28672
    ds_read_b64_tr_b16 v[106:107], v14 offset:29184
    ds_read_b64_tr_b16 v[108:109], v15 offset:28672
    ds_read_b64_tr_b16 v[110:111], v15 offset:29184
    s_waitcnt lgkmcnt(10)
    v_mfma_f32_16x16x32_bf16 v[32:35], v[80:83], v[76:79], v[32:35]
    v_mfma_f32_16x16x32_bf16 v[36:39], v[84:87], v[76:79], v[36:39]
    s_waitcnt lgkmcnt(5)
    v_mfma_f32_16x16x32_bf16 v[32:35], v[92:95], v[88:91], v[32:35]
    v_mfma_f32_16x16x32_bf16 v[36:39], v[96:99], v[88:91], v[36:39]
    s_waitcnt lgkmcnt(0)
    v_mfma_f32_16x16x32_bf16 v[32:35], v[104:107], v[100:103], v[32:35]
    v_mfma_f32_16x16x32_bf16 v[36:39], v[108:111], v[100:103], v[36:39]
    s_load_dwordx2 s[4:5], s[58:59], 0
    s_barrier
    ds_read_b128 v[64:67], v18 offset:49152
    ds_read_b64_tr_b16 v[68:69], v12 offset:0
    ds_read_b64_tr_b16 v[70:71], v12 offset:512
    ds_read_b64_tr_b16 v[72:73], v13 offset:0
    ds_read_b64_tr_b16 v[74:75], v13 offset:512
    ds_read_b128 v[76:79], v19 offset:49152
    ds_read_b64_tr_b16 v[80:81], v12 offset:4096
    ds_read_b64_tr_b16 v[82:83], v12 offset:4608
    ds_read_b64_tr_b16 v[84:85], v13 offset:4096
    ds_read_b64_tr_b16 v[86:87], v13 offset:4608
    ds_read_b128 v[88:91], v20 offset:49152
    ds_read_b64_tr_b16 v[92:93], v12 offset:8192
    ds_read_b64_tr_b16 v[94:95], v12 offset:8704
    ds_read_b64_tr_b16 v[96:97], v13 offset:8192
    ds_read_b64_tr_b16 v[98:99], v13 offset:8704
    s_waitcnt lgkmcnt(10)
    v_mfma_f32_16x16x32_bf16 v[32:35], v[68:71], v[64:67], v[32:35]
    v_mfma_f32_16x16x32_bf16 v[36:39], v[72:75], v[64:67], v[36:39]
    ds_read_b128 v[100:103], v21 offset:49152
    ds_read_b64_tr_b16 v[104:105], v12 offset:12288
    ds_read_b64_tr_b16 v[106:107], v12 offset:12800
    ds_read_b64_tr_b16 v[108:109], v13 offset:12288
    ds_read_b64_tr_b16 v[110:111], v13 offset:12800
    s_waitcnt lgkmcnt(10)
    v_mfma_f32_16x16x32_bf16 v[32:35], v[80:83], v[76:79], v[32:35]
    v_mfma_f32_16x16x32_bf16 v[36:39], v[84:87], v[76:79], v[36:39]
    s_waitcnt lgkmcnt(5)
    v_mfma_f32_16x16x32_bf16 v[32:35], v[92:95], v[88:91], v[32:35]
    v_mfma_f32_16x16x32_bf16 v[36:39], v[96:99], v[88:91], v[36:39]
    s_waitcnt lgkmcnt(0)
    v_mfma_f32_16x16x32_bf16 v[32:35], v[104:107], v[100:103], v[32:35]
    v_mfma_f32_16x16x32_bf16 v[36:39], v[108:111], v[100:103], v[36:39]
    s_barrier
    ds_read_b128 v[64:67], v18 offset:57344
    ds_read_b64_tr_b16 v[68:69], v12 offset:16384
    ds_read_b64_tr_b16 v[70:71], v12 offset:16896
    ds_read_b128 v[76:79], v19 offset:57344
    ds_read_b64_tr_b16 v[80:81], v12 offset:20480
    ds_read_b64_tr_b16 v[82:83], v12 offset:20992
    ds_read_b128 v[88:91], v20 offset:57344
    ds_read_b64_tr_b16 v[92:93], v12 offset:24576
    ds_read_b64_tr_b16 v[94:95], v12 offset:25088
    ds_read_b128 v[100:103], v21 offset:57344
    ds_read_b64_tr_b16 v[104:105], v12 offset:28672
    ds_read_b64_tr_b16 v[106:107], v12 offset:29184
    ds_read_b64_tr_b16 v[72:73], v13 offset:16384
    ds_read_b64_tr_b16 v[74:75], v13 offset:16896
    s_waitcnt lgkmcnt(11)
    v_mfma_f32_16x16x32_bf16 v[32:35], v[68:71], v[64:67], v[32:35]
    ds_read_b64_tr_b16 v[84:85], v13 offset:20480
    ds_read_b64_tr_b16 v[86:87], v13 offset:20992
    s_waitcnt lgkmcnt(10)
    v_mfma_f32_16x16x32_bf16 v[32:35], v[80:83], v[76:79], v[32:35]
    ds_read_b64_tr_b16 v[96:97], v13 offset:24576
    ds_read_b64_tr_b16 v[98:99], v13 offset:25088
    s_waitcnt lgkmcnt(9)
    v_mfma_f32_16x16x32_bf16 v[32:35], v[92:95], v[88:91], v[32:35]
    ds_read_b64_tr_b16 v[108:109], v13 offset:28672
    ds_read_b64_tr_b16 v[110:111], v13 offset:29184
    s_waitcnt lgkmcnt(8)
    v_mfma_f32_16x16x32_bf16 v[32:35], v[104:107], v[100:103], v[32:35]
    s_cmp_lg_u32 s3, 0
    s_cbranch_scc0 L_gate
    s_waitcnt lgkmcnt(6)
    v_mfma_f32_16x16x32_bf16 v[36:39], v[72:75], v[64:67], v[36:39]
    s_waitcnt lgkmcnt(4)
    v_mfma_f32_16x16x32_bf16 v[36:39], v[84:87], v[76:79], v[36:39]
    s_waitcnt lgkmcnt(2)
    v_mfma_f32_16x16x32_bf16 v[36:39], v[96:99], v[88:91], v[36:39]
    s_waitcnt lgkmcnt(0)
    v_mfma_f32_16x16x32_bf16 v[36:39], v[108:111], v[100:103], v[36:39]
    s_nop 7
    v_cvt_pk_bf16_f32 v56, v32, v33
    v_cvt_pk_bf16_f32 v57, v34, v35
    v_cvt_pk_bf16_f32 v58, v36, v37
    v_cvt_pk_bf16_f32 v59, v38, v39
    s_branch L_up
L_gate:
    s_waitcnt lgkmcnt(6)
    v_mfma_f32_16x16x32_bf16 v[36:39], v[72:75], v[64:67], v[36:39]
    s_nop 5
    v_cvt_pk_bf16_f32 v56, v32, v33
    v_cvt_pk_bf16_f32 v57, v34, v35
    v_lshlrev_b32 v32, 16, v56
    v_and_b32 v33, 0xffff0000, v56
    v_lshlrev_b32 v34, 16, v57
    v_and_b32 v35, 0xffff0000, v57
    v_mul_f32 v44, 0xbfb8aa3b, v32
    v_mul_f32 v45, 0xbfb8aa3b, v33
    v_mul_f32 v46, 0xbfb8aa3b, v34
    v_mul_f32 v47, 0xbfb8aa3b, v35
    s_waitcnt lgkmcnt(4)
    v_mfma_f32_16x16x32_bf16 v[36:39], v[84:87], v[76:79], v[36:39]
    v_exp_f32 v44, v44
    v_exp_f32 v45, v45
    v_exp_f32 v46, v46
    v_exp_f32 v47, v47
    s_waitcnt lgkmcnt(2)
    v_mfma_f32_16x16x32_bf16 v[36:39], v[96:99], v[88:91], v[36:39]
    v_add_f32 v44, 1.0, v44
    v_add_f32 v45, 1.0, v45
    v_add_f32 v46, 1.0, v46
    v_add_f32 v47, 1.0, v47
    s_waitcnt lgkmcnt(0)
    v_mfma_f32_16x16x32_bf16 v[36:39], v[108:111], v[100:103], v[36:39]
    v_rcp_f32 v44, v44
    v_rcp_f32 v45, v45
    v_rcp_f32 v46, v46
    v_rcp_f32 v47, v47
    v_mul_f32 v32, v32, v44
    v_mul_f32 v33, v33, v45
    v_mul_f32 v34, v34, v46
    v_mul_f32 v35, v35, v47
    v_cvt_pk_bf16_f32 v56, v32, v33
    v_cvt_pk_bf16_f32 v57, v34, v35
    v_cvt_pk_bf16_f32 v58, v36, v37
    v_cvt_pk_bf16_f32 v59, v38, v39
    v_lshlrev_b32 v36, 16, v58
    v_and_b32 v37, 0xffff0000, v58
    v_lshlrev_b32 v38, 16, v59
    v_and_b32 v39, 0xffff0000, v59
    v_mul_f32 v48, 0xbfb8aa3b, v36
    v_mul_f32 v49, 0xbfb8aa3b, v37
    v_mul_f32 v50, 0xbfb8aa3b, v38
    v_mul_f32 v51, 0xbfb8aa3b, v39
    v_exp_f32 v48, v48
    v_exp_f32 v49, v49
    v_exp_f32 v50, v50
    v_exp_f32 v51, v51
    v_add_f32 v48, 1.0, v48
    v_add_f32 v49, 1.0, v49
    v_add_f32 v50, 1.0, v50
    v_add_f32 v51, 1.0, v51
    v_rcp_f32 v48, v48
    v_rcp_f32 v49, v49
    v_rcp_f32 v50, v50
    v_rcp_f32 v51, v51
    v_mul_f32 v36, v36, v48
    v_mul_f32 v37, v37, v49
    v_mul_f32 v38, v38, v50
    v_mul_f32 v39, v39, v51
    v_cvt_pk_bf16_f32 v58, v36, v37
    v_cvt_pk_bf16_f32 v59, v38, v39
L_up:
    s_cmp_ge_u32 s4, 32
    s_cbranch_scc1 L_fok0
    s_mov_b32 s43, 0
    v_mov_b32 v7, 0
L_fl0:
    s_sleep 8
    buffer_load_dwordx2 v[8:9], v7, s[24:27], 0 offen sc1
    s_waitcnt vmcnt(0)
    v_readfirstlane_b32 s4, v8
    v_readfirstlane_b32 s5, v9
    s_add_u32 s43, s43, 1
    s_cmp_gt_u32 s43, 20000
    s_cbranch_scc1 L_fok0
    s_cmp_lt_u32 s4, 32
    s_cbranch_scc1 L_fl0
L_fok0:
    v_min_u32 v56, -2, v56
    v_min_u32 v57, -2, v57
    v_min_u32 v58, -2, v58
    v_min_u32 v59, -2, v59
    buffer_store_dwordx4 v[56:59], v5, s[28:31], 0 offen
L_nw:
    v_mov_b32 v61, s5
    ds_write_b32 v23, v61
    v_mov_b32 v60, v59
    v_lshrrev_b32 v62, 1, v5
    v_mov_b32 v59, v61
    s_waitcnt lgkmcnt(0)
    s_barrier
L_p2_1:
    buffer_load_dwordx4 v[176:179], v10, s[28:31], 0 offen offset:0 sc1
    buffer_load_dwordx4 v[204:207], v10, s[28:31], s90 offen offset:0 sc1
    buffer_load_dwordx4 v[180:183], v10, s[28:31], 0 offen offset:1024 sc1
    buffer_load_dwordx4 v[208:211], v10, s[28:31], s90 offen offset:1024 sc1
    buffer_load_dwordx4 v[184:187], v10, s[28:31], 0 offen offset:2048 sc1
    buffer_load_dwordx4 v[212:215], v10, s[28:31], s90 offen offset:2048 sc1
    buffer_load_dwordx4 v[188:191], v10, s[28:31], 0 offen offset:3072 sc1
    buffer_load_dwordx4 v[216:219], v10, s[28:31], s90 offen offset:3072 sc1
    ds_read_b32 v12, v23
    ds_read_b64_tr_b16 v[64:65], v28 offset:0
    ds_read_b64_tr_b16 v[66:67], v28 offset:2048
    ds_read_b64_tr_b16 v[68:69], v29 offset:0
    ds_read_b64_tr_b16 v[70:71], v29 offset:2048
    ds_read_b64_tr_b16 v[72:73], v30 offset:0
    ds_read_b64_tr_b16 v[74:75], v30 offset:2048
    ds_read_b64_tr_b16 v[76:77], v31 offset:0
    ds_read_b64_tr_b16 v[78:79], v31 offset:2048
    ds_read_b64_tr_b16 v[80:81], v24 offset:0
    ds_read_b64_tr_b16 v[82:83], v24 offset:2048
    ds_read_b64_tr_b16 v[84:85], v25 offset:0
    ds_read_b64_tr_b16 v[86:87], v25 offset:2048
    ds_read_b64_tr_b16 v[88:89], v26 offset:0
    ds_read_b64_tr_b16 v[90:91], v26 offset:2048
    ds_read_b64_tr_b16 v[92:93], v27 offset:0
    ds_read_b64_tr_b16 v[94:95], v27 offset:2048
    ds_read_b64_tr_b16 v[96:97], v24 offset:8192
    ds_read_b64_tr_b16 v[98:99], v24 offset:10240
    ds_read_b64_tr_b16 v[100:101], v25 offset:8192
    ds_read_b64_tr_b16 v[102:103], v25 offset:10240
    ds_read_b64_tr_b16 v[104:105], v26 offset:8192
    ds_read_b64_tr_b16 v[106:107], v26 offset:10240
    ds_read_b64_tr_b16 v[108:109], v27 offset:8192
    ds_read_b64_tr_b16 v[110:111], v27 offset:10240
    ds_read_b64_tr_b16 v[112:113], v24 offset:16384
    ds_read_b64_tr_b16 v[114:115], v24 offset:18432
    ds_read_b64_tr_b16 v[116:117], v25 offset:16384
    ds_read_b64_tr_b16 v[118:119], v25 offset:18432
    ds_read_b64_tr_b16 v[120:121], v26 offset:16384
    ds_read_b64_tr_b16 v[122:123], v26 offset:18432
    ds_read_b64_tr_b16 v[124:125], v27 offset:16384
    ds_read_b64_tr_b16 v[126:127], v27 offset:18432
    s_mov_b32 s43, 0
    s_mov_b32 s41, 0xffff0000
L_h10:
    s_waitcnt vmcnt(6)
    v_max3_u32 v8, v176, v177, v178
    v_max3_u32 v9, v204, v205, v206
    v_max3_u32 v8, v8, v179, v207
    v_max_u32 v8, v8, v9
    v_cmp_eq_u32 vcc, -1, v8
    s_cbranch_vccnz L_r10
L_g10:
    v_lshlrev_b32 v44, 16, v176
    v_and_b32 v45, s41, v176
    v_lshlrev_b32 v144, 16, v204
    v_and_b32 v145, s41, v204
    v_pk_mul_f32 v[44:45], v[44:45], v[144:145]
    v_lshlrev_b32 v46, 16, v177
    v_and_b32 v47, s41, v177
    v_lshlrev_b32 v146, 16, v205
    v_and_b32 v147, s41, v205
    v_pk_mul_f32 v[46:47], v[46:47], v[146:147]
    v_lshlrev_b32 v48, 16, v178
    v_and_b32 v49, s41, v178
    v_lshlrev_b32 v148, 16, v206
    v_and_b32 v149, s41, v206
    v_pk_mul_f32 v[48:49], v[48:49], v[148:149]
    v_lshlrev_b32 v50, 16, v179
    v_and_b32 v51, s41, v179
    v_lshlrev_b32 v150, 16, v207
    v_and_b32 v151, s41, v207
    v_pk_mul_f32 v[50:51], v[50:51], v[150:151]
    v_cvt_pk_bf16_f32 v176, v44, v45
    v_cvt_pk_bf16_f32 v177, v46, v47
    v_cvt_pk_bf16_f32 v178, v48, v49
    v_cvt_pk_bf16_f32 v179, v50, v51
    s_waitcnt lgkmcnt(0)
    s_nop 0
    v_mfma_f32_16x16x32_bf16 v[240:243], v[72:75], v[176:179], 0
    v_mfma_f32_16x16x32_bf16 v[244:247], v[76:79], v[176:179], 0
    v_mfma_f32_16x16x32_bf16 v[232:235], v[64:67], v[176:179], 0
    v_mfma_f32_16x16x32_bf16 v[236:239], v[68:71], v[176:179], 0
L_h11:
    s_waitcnt vmcnt(4)
    v_max3_u32 v8, v180, v181, v182
    v_max3_u32 v9, v208, v209, v210
    v_max3_u32 v8, v8, v183, v211
    v_max_u32 v8, v8, v9
    v_cmp_eq_u32 vcc, -1, v8
    s_cbranch_vccnz L_r11
L_g11:
    v_lshlrev_b32 v44, 16, v180
    v_and_b32 v45, s41, v180
    v_lshlrev_b32 v144, 16, v208
    v_and_b32 v145, s41, v208
    v_pk_mul_f32 v[44:45], v[44:45], v[144:145]
    v_lshlrev_b32 v46, 16, v181
    v_and_b32 v47, s41, v181
    v_lshlrev_b32 v146, 16, v209
    v_and_b32 v147, s41, v209
    v_pk_mul_f32 v[46:47], v[46:47], v[146:147]
    v_lshlrev_b32 v48, 16, v182
    v_and_b32 v49, s41, v182
    v_lshlrev_b32 v148, 16, v210
    v_and_b32 v149, s41, v210
    v_pk_mul_f32 v[48:49], v[48:49], v[148:149]
    v_lshlrev_b32 v50, 16, v183
    v_and_b32 v51, s41, v183
    v_lshlrev_b32 v150, 16, v211
    v_and_b32 v151, s41, v211
    v_pk_mul_f32 v[50:51], v[50:51], v[150:151]
    v_cvt_pk_bf16_f32 v180, v44, v45
    v_cvt_pk_bf16_f32 v181, v46, v47
    v_cvt_pk_bf16_f32 v182, v48, v49
    v_cvt_pk_bf16_f32 v183, v50, v51
    s_nop 0
    s_nop 0
    v_mfma_f32_16x16x32_bf16 v[240:243], v[88:91], v[180:183], v[240:243]
    v_mfma_f32_16x16x32_bf16 v[244:247], v[92:95], v[180:183], v[244:247]
    v_mfma_f32_16x16x32_bf16 v[232:235], v[80:83], v[180:183], v[232:235]
    v_mfma_f32_16x16x32_bf16 v[236:239], v[84:87], v[180:183], v[236:239]
L_h12:
    s_waitcnt vmcnt(2)
    v_max3_u32 v8, v184, v185, v186
    v_max3_u32 v9, v212, v213, v214
    v_max3_u32 v8, v8, v187, v215
    v_max_u32 v8, v8, v9
    v_cmp_eq_u32 vcc, -1, v8
    s_cbranch_vccnz L_r12
L_g12:
    v_lshlrev_b32 v44, 16, v184
    v_and_b32 v45, s41, v184
    v_lshlrev_b32 v144, 16, v212
    v_and_b32 v145, s41, v212
    v_pk_mul_f32 v[44:45], v[44:45], v[144:145]
    v_lshlrev_b32 v46, 16, v185
    v_and_b32 v47, s41, v185
    v_lshlrev_b32 v146, 16, v213
    v_and_b32 v147, s41, v213
    v_pk_mul_f32 v[46:47], v[46:47], v[146:147]
    v_lshlrev_b32 v48, 16, v186
    v_and_b32 v49, s41, v186
    v_lshlrev_b32 v148, 16, v214
    v_and_b32 v149, s41, v214
    v_pk_mul_f32 v[48:49], v[48:49], v[148:149]
    v_lshlrev_b32 v50, 16, v187
    v_and_b32 v51, s41, v187
    v_lshlrev_b32 v150, 16, v215
    v_and_b32 v151, s41, v215
    v_pk_mul_f32 v[50:51], v[50:51], v[150:151]
    v_cvt_pk_bf16_f32 v184, v44, v45
    v_cvt_pk_bf16_f32 v185, v46, v47
    v_cvt_pk_bf16_f32 v186, v48, v49
    v_cvt_pk_bf16_f32 v187, v50, v51
    s_nop 0
    s_nop 0
    v_mfma_f32_16x16x32_bf16 v[240:243], v[104:107], v[184:187], v[240:243]
    v_mfma_f32_16x16x32_bf16 v[244:247], v[108:111], v[184:187], v[244:247]
    v_mfma_f32_16x16x32_bf16 v[232:235], v[96:99], v[184:187], v[232:235]
    v_mfma_f32_16x16x32_bf16 v[236:239], v[100:103], v[184:187], v[236:239]
L_h13:
    s_waitcnt vmcnt(0)
    v_max3_u32 v8, v188, v189, v190
    v_max3_u32 v9, v216, v217, v218
    v_max3_u32 v8, v8, v191, v219
    v_max_u32 v8, v8, v9
    v_cmp_eq_u32 vcc, -1, v8
    s_cbranch_vccnz L_r13
L_g13:
    v_lshlrev_b32 v44, 16, v188
    v_and_b32 v45, s41, v188
    v_lshlrev_b32 v144, 16, v216
    v_and_b32 v145, s41, v216
    v_pk_mul_f32 v[44:45], v[44:45], v[144:145]
    v_lshlrev_b32 v46, 16, v189
    v_and_b32 v47, s41, v189
    v_lshlrev_b32 v146, 16, v217
    v_and_b32 v147, s41, v217
    v_pk_mul_f32 v[46:47], v[46:47], v[146:147]
    v_lshlrev_b32 v48, 16, v190
    v_and_b32 v49, s41, v190
    v_lshlrev_b32 v148, 16, v218
    v_and_b32 v149, s41, v218
    v_pk_mul_f32 v[48:49], v[48:49], v[148:149]
    v_lshlrev_b32 v50, 16, v191
    v_and_b32 v51, s41, v191
    v_lshlrev_b32 v150, 16, v219
    v_and_b32 v151, s41, v219
    v_pk_mul_f32 v[50:51], v[50:51], v[150:151]
    v_cvt_pk_bf16_f32 v188, v44, v45
    v_cvt_pk_bf16_f32 v189, v46, v47
    v_cvt_pk_bf16_f32 v190, v48, v49
    v_cvt_pk_bf16_f32 v191, v50, v51
    s_nop 0
    s_nop 0
    v_mfma_f32_16x16x32_bf16 v[240:243], v[120:123], v[188:191], v[240:243]
    v_mfma_f32_16x16x32_bf16 v[244:247], v[124:127], v[188:191], v[244:247]
    v_mfma_f32_16x16x32_bf16 v[232:235], v[112:115], v[188:191], v[232:235]
    v_mfma_f32_16x16x32_bf16 v[236:239], v[116:119], v[188:191], v[236:239]
    s_cmp_ge_u32 s33, 28
    s_cbranch_scc1 L_pfm
    buffer_store_dwordx4 v[56:59], v5, s[28:31], s94 offen sc1
    buffer_store_dwordx2 v[60:61], v62, s[28:31], s95 offen sc1
L_pfm:
    s_mov_b32 s52, 117835008
    s_mov_b32 s53, 117835009
    s_mov_b32 s54, 117835010
    s_mov_b32 s55, 117835011
    s_movk_i32 s41, 0x2000
    s_nop 0
    ds_write_b128 v3, v[240:243] offset:0
    ds_write_b128 v3, v[244:247] offset:3072
    s_waitcnt lgkmcnt(0)
    s_barrier
    ds_read_b128 v[64:67], v11 offset:0
    ds_read_b128 v[68:71], v11 offset:1024
    ds_read_b128 v[72:75], v11 offset:2048
    ds_read_b128 v[76:79], v11 offset:3072
    ds_read_b128 v[80:83], v11 offset:4096
    ds_read_b128 v[84:87], v11 offset:5120
    s_waitcnt lgkmcnt(5)
    v_pk_add_f32 v[232:233], v[232:233], v[64:65]
    v_pk_add_f32 v[234:235], v[234:235], v[66:67]
    s_waitcnt lgkmcnt(4)
    v_pk_add_f32 v[232:233], v[232:233], v[68:69]
    v_pk_add_f32 v[234:235], v[234:235], v[70:71]
    s_waitcnt lgkmcnt(3)
    v_pk_add_f32 v[232:233], v[232:233], v[72:73]
    v_pk_add_f32 v[234:235], v[234:235], v[74:75]
    v_perm_b32 v232, v232, v12, s52
    v_perm_b32 v233, v233, v12, s53
    v_perm_b32 v234, v234, v12, s54
    v_perm_b32 v235, v235, v12, s55
    buffer_store_dwordx4 v[232:235], v6, s[28:31], 0 offen sc1
    s_waitcnt lgkmcnt(2)
    v_pk_add_f32 v[236:237], v[236:237], v[76:77]
    v_pk_add_f32 v[238:239], v[238:239], v[78:79]
    s_waitcnt lgkmcnt(1)
    v_pk_add_f32 v[236:237], v[236:237], v[80:81]
    v_pk_add_f32 v[238:239], v[238:239], v[82:83]
    s_waitcnt lgkmcnt(0)
    v_pk_add_f32 v[236:237], v[236:237], v[84:85]
    v_pk_add_f32 v[238:239], v[238:239], v[86:87]
    v_perm_b32 v236, v236, v12, s52
    v_perm_b32 v237, v237, v12, s53
    v_perm_b32 v238, v238, v12, s54
    v_perm_b32 v239, v239, v12, s55
    buffer_store_dwordx4 v[236:239], v6, s[28:31], s41 offen sc1
    s_endpgm
L_p2_0:
    buffer_load_dwordx4 v[176:179], v10, s[28:31], 0 offen offset:0 sc1
    buffer_load_dwordx4 v[204:207], v10, s[28:31], s90 offen offset:0 sc1
    buffer_load_dwordx4 v[180:183], v10, s[28:31], 0 offen offset:1024 sc1
    buffer_load_dwordx4 v[208:211], v10, s[28:31], s90 offen offset:1024 sc1
    buffer_load_dwordx4 v[184:187], v10, s[28:31], 0 offen offset:2048 sc1
    buffer_load_dwordx4 v[212:215], v10, s[28:31], s90 offen offset:2048 sc1
    ds_read_b32 v12, v23
    ds_read_b64_tr_b16 v[64:65], v24 offset:0
    ds_read_b64_tr_b16 v[66:67], v24 offset:2048
    ds_read_b64_tr_b16 v[68:69], v25 offset:0
    ds_read_b64_tr_b16 v[70:71], v25 offset:2048
    ds_read_b64_tr_b16 v[72:73], v26 offset:0
    ds_read_b64_tr_b16 v[74:75], v26 offset:2048
    ds_read_b64_tr_b16 v[76:77], v27 offset:0
    ds_read_b64_tr_b16 v[78:79], v27 offset:2048
    ds_read_b64_tr_b16 v[80:81], v24 offset:8192
    ds_read_b64_tr_b16 v[82:83], v24 offset:10240
    ds_read_b64_tr_b16 v[84:85], v25 offset:8192
    ds_read_b64_tr_b16 v[86:87], v25 offset:10240
    ds_read_b64_tr_b16 v[88:89], v26 offset:8192
    ds_read_b64_tr_b16 v[90:91], v26 offset:10240
    ds_read_b64_tr_b16 v[92:93], v27 offset:8192
    ds_read_b64_tr_b16 v[94:95], v27 offset:10240
    ds_read_b64_tr_b16 v[96:97], v24 offset:16384
    ds_read_b64_tr_b16 v[98:99], v24 offset:18432
    ds_read_b64_tr_b16 v[100:101], v25 offset:16384
    ds_read_b64_tr_b16 v[102:103], v25 offset:18432
    ds_read_b64_tr_b16 v[104:105], v26 offset:16384
    ds_read_b64_tr_b16 v[106:107], v26 offset:18432
    ds_read_b64_tr_b16 v[108:109], v27 offset:16384
    ds_read_b64_tr_b16 v[110:111], v27 offset:18432
    s_mov_b32 s43, 0
    s_mov_b32 s41, 0xffff0000
L_h00:
    s_waitcnt vmcnt(4)
    v_max3_u32 v8, v176, v177, v178
    v_max3_u32 v9, v204, v205, v206
    v_max3_u32 v8, v8, v179, v207
    v_max_u32 v8, v8, v9
    v_cmp_eq_u32 vcc, -1, v8
    s_cbranch_vccnz L_r00
L_g00:
    v_lshlrev_b32 v44, 16, v176
    v_and_b32 v45, s41, v176
    v_lshlrev_b32 v144, 16, v204
    v_and_b32 v145, s41, v204
    v_pk_mul_f32 v[44:45], v[44:45], v[144:145]
    v_lshlrev_b32 v46, 16, v177
    v_and_b32 v47, s41, v177
    v_lshlrev_b32 v146, 16, v205
    v_and_b32 v147, s41, v205
    v_pk_mul_f32 v[46:47], v[46:47], v[146:147]
    v_lshlrev_b32 v48, 16, v178
    v_and_b32 v49, s41, v178
    v_lshlrev_b32 v148, 16, v206
    v_and_b32 v149, s41, v206
    v_pk_mul_f32 v[48:49], v[48:49], v[148:149]
    v_lshlrev_b32 v50, 16, v179
    v_and_b32 v51, s41, v179
    v_lshlrev_b32 v150, 16, v207
    v_and_b32 v151, s41, v207
    v_pk_mul_f32 v[50:51], v[50:51], v[150:151]
    v_cvt_pk_bf16_f32 v176, v44, v45
    v_cvt_pk_bf16_f32 v177, v46, v47
    v_cvt_pk_bf16_f32 v178, v48, v49
    v_cvt_pk_bf16_f32 v179, v50, v51
    s_waitcnt lgkmcnt(0)
    s_nop 0
    v_mfma_f32_16x16x32_bf16 v[240:243], v[72:75], v[176:179], 0
    v_mfma_f32_16x16x32_bf16 v[244:247], v[76:79], v[176:179], 0
    v_mfma_f32_16x16x32_bf16 v[232:235], v[64:67], v[176:179], 0
    v_mfma_f32_16x16x32_bf16 v[236:239], v[68:71], v[176:179], 0
L_h01:
    s_waitcnt vmcnt(2)
    v_max3_u32 v8, v180, v181, v182
    v_max3_u32 v9, v208, v209, v210
    v_max3_u32 v8, v8, v183, v211
    v_max_u32 v8, v8, v9
    v_cmp_eq_u32 vcc, -1, v8
    s_cbranch_vccnz L_r01
L_g01:
    v_lshlrev_b32 v44, 16, v180
    v_and_b32 v45, s41, v180
    v_lshlrev_b32 v144, 16, v208
    v_and_b32 v145, s41, v208
    v_pk_mul_f32 v[44:45], v[44:45], v[144:145]
    v_lshlrev_b32 v46, 16, v181
    v_and_b32 v47, s41, v181
    v_lshlrev_b32 v146, 16, v209
    v_and_b32 v147, s41, v209
    v_pk_mul_f32 v[46:47], v[46:47], v[146:147]
    v_lshlrev_b32 v48, 16, v182
    v_and_b32 v49, s41, v182
    v_lshlrev_b32 v148, 16, v210
    v_and_b32 v149, s41, v210
    v_pk_mul_f32 v[48:49], v[48:49], v[148:149]
    v_lshlrev_b32 v50, 16, v183
    v_and_b32 v51, s41, v183
    v_lshlrev_b32 v150, 16, v211
    v_and_b32 v151, s41, v211
    v_pk_mul_f32 v[50:51], v[50:51], v[150:151]
    v_cvt_pk_bf16_f32 v180, v44, v45
    v_cvt_pk_bf16_f32 v181, v46, v47
    v_cvt_pk_bf16_f32 v182, v48, v49
    v_cvt_pk_bf16_f32 v183, v50, v51
    s_nop 0
    s_nop 0
    v_mfma_f32_16x16x32_bf16 v[240:243], v[88:91], v[180:183], v[240:243]
    v_mfma_f32_16x16x32_bf16 v[244:247], v[92:95], v[180:183], v[244:247]
    v_mfma_f32_16x16x32_bf16 v[232:235], v[80:83], v[180:183], v[232:235]
    v_mfma_f32_16x16x32_bf16 v[236:239], v[84:87], v[180:183], v[236:239]
L_h02:
    s_waitcnt vmcnt(0)
    v_max3_u32 v8, v184, v185, v186
    v_max3_u32 v9, v212, v213, v214
    v_max3_u32 v8, v8, v187, v215
    v_max_u32 v8, v8, v9
    v_cmp_eq_u32 vcc, -1, v8
    s_cbranch_vccnz L_r02
L_g02:
    v_lshlrev_b32 v44, 16, v184
    v_and_b32 v45, s41, v184
    v_lshlrev_b32 v144, 16, v212
    v_and_b32 v145, s41, v212
    v_pk_mul_f32 v[44:45], v[44:45], v[144:145]
    v_lshlrev_b32 v46, 16, v185
    v_and_b32 v47, s41, v185
    v_lshlrev_b32 v146, 16, v213
    v_and_b32 v147, s41, v213
    v_pk_mul_f32 v[46:47], v[46:47], v[146:147]
    v_lshlrev_b32 v48, 16, v186
    v_and_b32 v49, s41, v186
    v_lshlrev_b32 v148, 16, v214
    v_and_b32 v149, s41, v214
    v_pk_mul_f32 v[48:49], v[48:49], v[148:149]
    v_lshlrev_b32 v50, 16, v187
    v_and_b32 v51, s41, v187
    v_lshlrev_b32 v150, 16, v215
    v_and_b32 v151, s41, v215
    v_pk_mul_f32 v[50:51], v[50:51], v[150:151]
    v_cvt_pk_bf16_f32 v184, v44, v45
    v_cvt_pk_bf16_f32 v185, v46, v47
    v_cvt_pk_bf16_f32 v186, v48, v49
    v_cvt_pk_bf16_f32 v187, v50, v51
    s_nop 0
    s_nop 0
    v_mfma_f32_16x16x32_bf16 v[240:243], v[104:107], v[184:187], v[240:243]
    v_mfma_f32_16x16x32_bf16 v[244:247], v[108:111], v[184:187], v[244:247]
    v_mfma_f32_16x16x32_bf16 v[232:235], v[96:99], v[184:187], v[232:235]
    v_mfma_f32_16x16x32_bf16 v[236:239], v[100:103], v[184:187], v[236:239]
    v_readfirstlane_b32 s5, v12
    s_nop 5
    ds_write_b128 v3, v[240:243] offset:1024
    ds_write_b128 v3, v[244:247] offset:4096
    ds_write_b128 v11, v[232:235] offset:2048
    ds_write_b128 v11, v[236:239] offset:5120
    s_waitcnt lgkmcnt(0)
    s_barrier
    s_bfe_u32 s52, s5, 524288
    s_bfe_u32 s53, s5, 524296
    s_bfe_u32 s54, s5, 524304
    s_bfe_u32 s55, s5, 524312
    s_mov_b32 s43, 0
    s_sleep 20
    buffer_load_dwordx4 v[64:67], v16, s[28:31], 0 offen sc1
    buffer_load_dwordx4 v[68:71], v16, s[28:31], s93 offen sc1
L_pp:
    s_waitcnt vmcnt(0)
    v_xor_b32 v40, s52, v64
    v_xor_b32 v41, s53, v65
    v_xor_b32 v42, s54, v66
    v_xor_b32 v43, s55, v67
    v_xor_b32 v44, s52, v68
    v_xor_b32 v45, s53, v69
    v_xor_b32 v46, s54, v70
    v_xor_b32 v47, s55, v71
    v_or3_b32 v8, v40, v41, v42
    v_or3_b32 v9, v43, v44, v45
    v_or3_b32 v8, v8, v46, v47
    v_or_b32 v8, v8, v9
    v_and_b32 v8, 0xff, v8
    v_cmp_ne_u32 vcc, 0, v8
    s_cbranch_vccz L_pok
    buffer_load_dwordx4 v[64:67], v16, s[28:31], 0 offen sc1
    buffer_load_dwordx4 v[68:71], v16, s[28:31], s93 offen sc1
    s_add_u32 s43, s43, 1
    s_cmp_lt_u32 s43, 20000
    s_cbranch_scc1 L_pp
L_pok:
    v_add_f32 v40, v40, v44
    v_add_f32 v41, v41, v45
    v_add_f32 v42, v42, v46
    v_add_f32 v43, v43, v47
    s_nop 0
    v_permlane32_swap_b32 v40, v42
    v_permlane32_swap_b32 v41, v43
    v_add_f32 v40, v40, v42
    v_add_f32 v41, v41, v43
    v_mov_b32 v42, v40
    v_mov_b32 v43, v41
    s_nop 1
    v_permlane16_swap_b32 v40, v42
    v_permlane16_swap_b32 v41, v43
    v_add_f32 v40, v40, v42
    v_add_f32 v41, v41, v43
    v_cvt_pk_bf16_f32 v40, v40, v41
    s_mov_b32 exec_lo, 0xffff
    s_mov_b32 exec_hi, 0xffff
    buffer_store_dword v40, v17, s[20:23], 0 offen
L_end:
    s_endpgm
L_r00:
    s_add_u32 s43, s43, 1
    s_cmp_gt_u32 s43, 20000
    s_cbranch_scc1 L_g00
    s_mov_b32 s7, 0
    s_cmp_ge_u32 s43, 12
    s_cbranch_scc1 L_slow0
L_rr00:
    s_sleep 1
    buffer_load_dwordx4 v[176:179], v10, s[28:31], 0 offen offset:0 sc1
    buffer_load_dwordx4 v[204:207], v10, s[28:31], s90 offen offset:0 sc1
    buffer_load_dwordx4 v[180:183], v10, s[28:31], 0 offen offset:1024 sc1
    buffer_load_dwordx4 v[208:211], v10, s[28:31], s90 offen offset:1024 sc1
    buffer_load_dwordx4 v[184:187], v10, s[28:31], 0 offen offset:2048 sc1
    buffer_load_dwordx4 v[212:215], v10, s[28:31], s90 offen offset:2048 sc1
    s_branch L_h00
L_r01:
    s_add_u32 s43, s43, 1
    s_cmp_gt_u32 s43, 20000
    s_cbranch_scc1 L_g01
    s_mov_b32 s7, 1
    s_cmp_ge_u32 s43, 12
    s_cbranch_scc1 L_slow0
L_rr01:
    s_sleep 1
    buffer_load_dwordx4 v[180:183], v10, s[28:31], 0 offen offset:1024 sc1
    buffer_load_dwordx4 v[208:211], v10, s[28:31], s90 offen offset:1024 sc1
    buffer_load_dwordx4 v[184:187], v10, s[28:31], 0 offen offset:2048 sc1
    buffer_load_dwordx4 v[212:215], v10, s[28:31], s90 offen offset:2048 sc1
    s_branch L_h01
L_r02:
    s_add_u32 s43, s43, 1
    s_cmp_gt_u32 s43, 20000
    s_cbranch_scc1 L_g02
    s_mov_b32 s7, 2
    s_cmp_ge_u32 s43, 12
    s_cbranch_scc1 L_slow0
L_rr02:
    s_sleep 1
    buffer_load_dwordx4 v[184:187], v10, s[28:31], 0 offen offset:2048 sc1
    buffer_load_dwordx4 v[212:215], v10, s[28:31], s90 offen offset:2048 sc1
    s_branch L_h02
L_slow0:
    v_lshrrev_b32 v63, 1, v10
    s_waitcnt lgkmcnt(0)
L_sl10:
    s_sleep 8
    buffer_load_dwordx4 v[176:179], v10, s[28:31], s94 offen offset:0 sc1
    buffer_load_dwordx2 v[128:129], v63, s[28:31], s95 offen offset:0 sc1
    buffer_load_dwordx4 v[204:207], v10, s[28:31], s96 offen offset:0 sc1
    buffer_load_dwordx2 v[130:131], v63, s[28:31], s97 offen offset:0 sc1
    buffer_load_dwordx4 v[180:183], v10, s[28:31], s94 offen offset:1024 sc1
    buffer_load_dwordx2 v[132:133], v63, s[28:31], s95 offen offset:512 sc1
    buffer_load_dwordx4 v[208:211], v10, s[28:31], s96 offen offset:1024 sc1
    buffer_load_dwordx2 v[134:135], v63, s[28:31], s97 offen offset:512 sc1
    buffer_load_dwordx4 v[184:187], v10, s[28:31], s94 offen offset:2048 sc1
    buffer_load_dwordx2 v[136:137], v63, s[28:31], s95 offen offset:1024 sc1
    buffer_load_dwordx4 v[212:215], v10, s[28:31], s96 offen offset:2048 sc1
    buffer_load_dwordx2 v[138:139], v63, s[28:31], s97 offen offset:1024 sc1
    s_waitcnt vmcnt(0)
    v_mov_b32 v8, 0
    v_xor_b32 v179, v179, v12
    v_xor_b32 v129, v129, v12
    v_or3_b32 v8, v8, v179, v129
    v_mov_b32 v179, v128
    v_xor_b32 v207, v207, v12
    v_xor_b32 v131, v131, v12
    v_or3_b32 v8, v8, v207, v131
    v_mov_b32 v207, v130
    v_xor_b32 v183, v183, v12
    v_xor_b32 v133, v133, v12
    v_or3_b32 v8, v8, v183, v133
    v_mov_b32 v183, v132
    v_xor_b32 v211, v211, v12
    v_xor_b32 v135, v135, v12
    v_or3_b32 v8, v8, v211, v135
    v_mov_b32 v211, v134
    v_xor_b32 v187, v187, v12
    v_xor_b32 v137, v137, v12
    v_or3_b32 v8, v8, v187, v137
    v_mov_b32 v187, v136
    v_xor_b32 v215, v215, v12
    v_xor_b32 v139, v139, v12
    v_or3_b32 v8, v8, v215, v139
    v_mov_b32 v215, v138
    s_add_u32 s43, s43, 1
    s_cmp_gt_u32 s43, 20000
    s_cbranch_scc1 L_sl20
    v_cmp_ne_u32 vcc, 0, v8
    s_cbranch_vccnz L_sl10
L_sl20:
    s_cmp_eq_u32 s7, 0
    s_cbranch_scc1 L_h00
    s_cmp_eq_u32 s7, 1
    s_cbranch_scc1 L_h01
    s_branch L_h02
L_r10:
    s_add_u32 s43, s43, 1
    s_cmp_gt_u32 s43, 20000
    s_cbranch_scc1 L_g10
    s_mov_b32 s7, 0
    s_cmp_ge_u32 s43, 12
    s_cbranch_scc1 L_slow1
L_rr10:
    s_sleep 1
    buffer_load_dwordx4 v[176:179], v10, s[28:31], 0 offen offset:0 sc1
    buffer_load_dwordx4 v[204:207], v10, s[28:31], s90 offen offset:0 sc1
    buffer_load_dwordx4 v[180:183], v10, s[28:31], 0 offen offset:1024 sc1
    buffer_load_dwordx4 v[208:211], v10, s[28:31], s90 offen offset:1024 sc1
    buffer_load_dwordx4 v[184:187], v10, s[28:31], 0 offen offset:2048 sc1
    buffer_load_dwordx4 v[212:215], v10, s[28:31], s90 offen offset:2048 sc1
    buffer_load_dwordx4 v[188:191], v10, s[28:31], 0 offen offset:3072 sc1
    buffer_load_dwordx4 v[216:219], v10, s[28:31], s90 offen offset:3072 sc1
    s_branch L_h10
L_r11:
    s_add_u32 s43, s43, 1
    s_cmp_gt_u32 s43, 20000
    s_cbranch_scc1 L_g11
    s_mov_b32 s7, 1
    s_cmp_ge_u32 s43, 12
    s_cbranch_scc1 L_slow1
L_rr11:
    s_sleep 1
    buffer_load_dwordx4 v[180:183], v10, s[28:31], 0 offen offset:1024 sc1
    buffer_load_dwordx4 v[208:211], v10, s[28:31], s90 offen offset:1024 sc1
    buffer_load_dwordx4 v[184:187], v10, s[28:31], 0 offen offset:2048 sc1
    buffer_load_dwordx4 v[212:215], v10, s[28:31], s90 offen offset:2048 sc1
    buffer_load_dwordx4 v[188:191], v10, s[28:31], 0 offen offset:3072 sc1
    buffer_load_dwordx4 v[216:219], v10, s[28:31], s90 offen offset:3072 sc1
    s_branch L_h11
L_r12:
    s_add_u32 s43, s43, 1
    s_cmp_gt_u32 s43, 20000
    s_cbranch_scc1 L_g12
    s_mov_b32 s7, 2
    s_cmp_ge_u32 s43, 12
    s_cbranch_scc1 L_slow1
L_rr12:
    s_sleep 1
    buffer_load_dwordx4 v[184:187], v10, s[28:31], 0 offen offset:2048 sc1
    buffer_load_dwordx4 v[212:215], v10, s[28:31], s90 offen offset:2048 sc1
    buffer_load_dwordx4 v[188:191], v10, s[28:31], 0 offen offset:3072 sc1
    buffer_load_dwordx4 v[216:219], v10, s[28:31], s90 offen offset:3072 sc1
    s_branch L_h12
L_r13:
    s_add_u32 s43, s43, 1
    s_cmp_gt_u32 s43, 20000
    s_cbranch_scc1 L_g13
    s_mov_b32 s7, 3
    s_cmp_ge_u32 s43, 12
    s_cbranch_scc1 L_slow1
L_rr13:
    s_sleep 1
    buffer_load_dwordx4 v[188:191], v10, s[28:31], 0 offen offset:3072 sc1
    buffer_load_dwordx4 v[216:219], v10, s[28:31], s90 offen offset:3072 sc1
    s_branch L_h13
L_slow1:
    s_cmp_ge_u32 s33, 28
    s_cbranch_scc1 L_pfs
    buffer_store_dwordx4 v[56:59], v5, s[28:31], s94 offen sc1
    buffer_store_dwordx2 v[60:61], v62, s[28:31], s95 offen sc1
L_pfs:
    v_lshrrev_b32 v63, 1, v10
    s_waitcnt lgkmcnt(0)
L_sl11:
    s_sleep 8
    buffer_load_dwordx4 v[176:179], v10, s[28:31], s94 offen offset:0 sc1
    buffer_load_dwordx2 v[128:129], v63, s[28:31], s95 offen offset:0 sc1
    buffer_load_dwordx4 v[204:207], v10, s[28:31], s96 offen offset:0 sc1
    buffer_load_dwordx2 v[130:131], v63, s[28:31], s97 offen offset:0 sc1
    buffer_load_dwordx4 v[180:183], v10, s[28:31], s94 offen offset:1024 sc1
    buffer_load_dwordx2 v[132:133], v63, s[28:31], s95 offen offset:512 sc1
    buffer_load_dwordx4 v[208:211], v10, s[28:31], s96 offen offset:1024 sc1
    buffer_load_dwordx2 v[134:135], v63, s[28:31], s97 offen offset:512 sc1
    buffer_load_dwordx4 v[184:187], v10, s[28:31], s94 offen offset:2048 sc1
    buffer_load_dwordx2 v[136:137], v63, s[28:31], s95 offen offset:1024 sc1
    buffer_load_dwordx4 v[212:215], v10, s[28:31], s96 offen offset:2048 sc1
    buffer_load_dwordx2 v[138:139], v63, s[28:31], s97 offen offset:1024 sc1
    buffer_load_dwordx4 v[188:191], v10, s[28:31], s94 offen offset:3072 sc1
    buffer_load_dwordx2 v[140:141], v63, s[28:31], s95 offen offset:1536 sc1
    buffer_load_dwordx4 v[216:219], v10, s[28:31], s96 offen offset:3072 sc1
    buffer_load_dwordx2 v[142:143], v63, s[28:31], s97 offen offset:1536 sc1
    s_waitcnt vmcnt(0)
    v_mov_b32 v8, 0
    v_xor_b32 v179, v179, v12
    v_xor_b32 v129, v129, v12
    v_or3_b32 v8, v8, v179, v129
    v_mov_b32 v179, v128
    v_xor_b32 v207, v207, v12
    v_xor_b32 v131, v131, v12
    v_or3_b32 v8, v8, v207, v131
    v_mov_b32 v207, v130
    v_xor_b32 v183, v183, v12
    v_xor_b32 v133, v133, v12
    v_or3_b32 v8, v8, v183, v133
    v_mov_b32 v183, v132
    v_xor_b32 v211, v211, v12
    v_xor_b32 v135, v135, v12
    v_or3_b32 v8, v8, v211, v135
    v_mov_b32 v211, v134
    v_xor_b32 v187, v187, v12
    v_xor_b32 v137, v137, v12
    v_or3_b32 v8, v8, v187, v137
    v_mov_b32 v187, v136
    v_xor_b32 v215, v215, v12
    v_xor_b32 v139, v139, v12
    v_or3_b32 v8, v8, v215, v139
    v_mov_b32 v215, v138
    v_xor_b32 v191, v191, v12
    v_xor_b32 v141, v141, v12
    v_or3_b32 v8, v8, v191, v141
    v_mov_b32 v191, v140
    v_xor_b32 v219, v219, v12
    v_xor_b32 v143, v143, v12
    v_or3_b32 v8, v8, v219, v143
    v_mov_b32 v219, v142
    s_add_u32 s43, s43, 1
    s_cmp_gt_u32 s43, 20000
    s_cbranch_scc1 L_sl21
    v_cmp_ne_u32 vcc, 0, v8
    s_cbranch_vccnz L_sl11
L_sl21:
    s_cmp_eq_u32 s7, 0
    s_cbranch_scc1 L_h10
    s_cmp_eq_u32 s7, 1
    s_cbranch_scc1 L_h11
    s_cmp_eq_u32 s7, 2
    s_cbranch_scc1 L_h12
    s_branch L_h13
L_hcp:
    s_cmp_lg_u32 s2, 224
    s_cbranch_scc1 L_hne
    s_add_u32 s46, s60, 4194304
    s_addc_u32 s47, s61, 0
    s_load_dword s5, s[46:47], 0
L_hne:
    v_mov_b32 v40, -1
    v_mov_b32 v41, -1
    v_mov_b32 v42, -1
    v_mov_b32 v43, -1
    s_sub_u32 s41, s2, 224
    s_lshl_b32 s41, s41, 2
    s_add_u32 s42, s41, s36
    s_mul_i32 s41, s42, 7168
    v_lshl_add_u32 v1, v0, 4, s41
    s_movk_i32 s41, 0
    buffer_store_dwordx4 v[40:43], v1, s[28:31], s41 offen offset:0 sc1
    buffer_store_dwordx4 v[40:43], v1, s[28:31], s41 offen offset:1024 sc1
    buffer_store_dwordx4 v[40:43], v1, s[28:31], s41 offen offset:2048 sc1
    buffer_store_dwordx4 v[40:43], v1, s[28:31], s41 offen offset:3072 sc1
    s_movk_i32 s41, 4096
    buffer_store_dwordx4 v[40:43], v1, s[28:31], s41 offen offset:0 sc1
    buffer_store_dwordx4 v[40:43], v1, s[28:31], s41 offen offset:1024 sc1
    buffer_store_dwordx4 v[40:43], v1, s[28:31], s41 offen offset:2048 sc1
    s_mov_b64 exec, 1
    v_mov_b32 v9, 0
    ds_write_b32 v9, v9
    s_waitcnt lgkmcnt(0)
    s_cmp_lg_u32 s42, 0
    s_cbranch_scc1 L_hc0
    s_add_u32 s5, s5, 1
    v_mov_b32 v8, s5
    s_mov_b32 s41, 4194304
    buffer_store_dword v8, v9, s[24:27], 0 offen offset:4 sc1
    buffer_store_dword v8, v9, s[28:31], s41 offen sc1
L_hc0:
    s_barrier
    v_mov_b32 v8, 1
    s_waitcnt vmcnt(0)
    ds_add_rtn_u32 v8, v9, v8
    s_waitcnt lgkmcnt(0)
    v_readfirstlane_b32 s41, v8
    s_mov_b64 exec, -1
    s_cmp_lg_u32 s41, 3
    s_cbranch_scc1 L_hc2
    s_mov_b32 s4, 1
    s_atomic_add s4, s[58:59], 0 glc
    s_waitcnt lgkmcnt(0)
L_hc2:
    s_lshl_b32 s42, s34, 1
    s_add_u32 s42, s42, s37
    s_mul_i32 s42, s42, 112
    s_mul_i32 s41, s3, 448
    s_add_u32 s41, s41, s42
    s_lshl_b32 s42, s43, 1
    s_add_u32 s41, s41, s42
    s_add_u32 s41, s41, s38
    s_lshl_b32 s41, s41, 10
    v_lshl_add_u32 v5, v0, 4, s41
    s_mov_b32 s94, 917504
    s_mov_b32 s95, 5242880
    s_mov_b32 s96, 1376256
    s_mov_b32 s97, 5472256
    s_mov_b32 s90, 458752
    s_lshl_b32 s91, s38, 1
    s_lshl_b32 s42, s34, 1
    s_add_u32 s42, s42, s37
    s_mul_i32 s42, s42, 112
    s_lshl_b32 s41, s32, 1
    s_add_u32 s41, s41, s38
    s_mul_i32 s41, s41, 7
    s_add_u32 s41, s41, s42
    s_add_u32 s41, s41, 0
    s_lshl_b32 s41, s41, 10
    v_lshl_add_u32 v10, v0, 4, s41
    s_lshl_b32 s92, s37, 2
    s_add_u32 s92, s92, s91
    s_lshl_b32 s41, s33, 3
    s_add_u32 s41, s41, s92
    s_lshl_b32 s41, s41, 3
    s_add_u32 s41, s41, s32
    s_lshl_b32 s41, s41, 10
    s_add_u32 s41, s41, 2097152
    v_lshl_add_u32 v6, v0, 4, s41
    v_and_b32 v9, 3, v0
    v_lshrrev_b32 v8, 2, v0
    v_lshlrev_b32 v24, 7, v8
    v_and_b32 v8, 6, v8
    v_lshl_add_u32 v24, v8, 4, v24
    v_lshl_add_u32 v24, v9, 3, v24
    s_lshl_b32 s41, s91, 5
    v_xor_b32 v24, s41, v24
    s_lshl_b32 s41, s38, 12
    s_add_u32 s41, s41, 32768
    v_add_u32 v24, s41, v24
    v_xor_b32 v25, 32, v24
    v_xor_b32 v26, 64, v24
    v_xor_b32 v27, 96, v24
    v_add_u32 v28, 0x10000, v24
    v_add_u32 v29, 0x10000, v25
    v_add_u32 v30, 0x10000, v26
    v_add_u32 v31, 0x10000, v27
    s_xor_b32 s41, s92, 0
    s_mul_i32 s41, s41, 3072
    s_add_u32 s41, s41, 106496
    v_lshl_add_u32 v11, v0, 4, s41
    s_xor_b32 s41, s92, 2
    s_mul_i32 s41, s41, 3072
    s_add_u32 s41, s41, 106496
    v_lshl_add_u32 v3, v0, 4, s41
    v_mov_b32 v23, 131072
    s_barrier
    s_load_dwordx2 s[4:5], s[58:59], 0
    s_waitcnt lgkmcnt(0)
    s_cmp_ge_u32 s4, 32
    s_cbranch_scc1 L_fok1
    s_mov_b32 s43, 0
    v_mov_b32 v7, 0
L_fl1:
    s_sleep 8
    buffer_load_dwordx2 v[8:9], v7, s[24:27], 0 offen sc1
    s_waitcnt vmcnt(0)
    v_readfirstlane_b32 s4, v8
    v_readfirstlane_b32 s5, v9
    s_add_u32 s43, s43, 1
    s_cmp_gt_u32 s43, 20000
    s_cbranch_scc1 L_fok1
    s_cmp_lt_u32 s4, 32
    s_cbranch_scc1 L_fl1
L_fok1:
    s_branch L_nw
.section .rodata,"a"
.p2align 6
.amdhsa_kernel standalone__glu_gated_swiglu__sampling_kernel
  .amdhsa_next_free_vgpr 256
  .amdhsa_next_free_sgpr 102
  .amdhsa_accum_offset 256
  .amdhsa_group_segment_fixed_size 0
  .amdhsa_kernarg_size 56
  .amdhsa_user_sgpr_count 2
  .amdhsa_user_sgpr_kernarg_segment_ptr 1
  .amdhsa_system_sgpr_workgroup_id_x 1
.end_amdhsa_kernel
```
